```python
import torch

def _softmax(x, axis=-1):
    return torch.softmax(x, dim=axis)
def _gelu(x):
    return torch.nn.functional.gelu(x, approximate="tanh")
def _silu(x):
    return torch.nn.functional.silu(x)
def _sigmoid(x):
    return torch.sigmoid(x)
def _layernorm(x, axis=-1, eps=1e-5):
    m = x.mean(dim=axis, keepdim=True)
    v = x.var(dim=axis, keepdim=True, unbiased=False)
    return (x - m) / torch.sqrt(v + eps)
def _scatter_add(tgt, idx, src, axis=0):
    return tgt.clone().index_add_(axis, idx, src)
def _segment_sum(src, seg, n):
    out = torch.zeros((n,) + src.shape[1:], dtype=src.dtype)
    return out.index_add_(0, seg, src)
def _pad(x, pw):
    flat = tuple(v for pair in reversed(pw) for v in pair)
    return torch.nn.functional.pad(x, flat)

kernel_name = 'recurrent_scan__mha_block__moe_arch_mod__prompt'

def setup_inputs():

    _w = (lambda a: (lambda t: t.to(torch.bfloat16) if t.is_floating_point() else t)(torch.as_tensor(a)))
    def _A_setup():
        B, S, D, H = 1, 2048, 448, 16
        return {
            "x": _w((lambda *s: torch.randn(*s, dtype=torch.bfloat16) * 0.05)(B, S, D)),
            "wqkv": _w((lambda *s: torch.randn(*s, dtype=torch.bfloat16) * 0.05)(D, 3 * D)),
            "wo": _w((lambda *s: torch.randn(*s, dtype=torch.bfloat16) * 0.05)(D, D)),
        }
    _A_in = _A_setup()

    def _B_setup():
        B, S, D, F, C = 1, 2048, 448, 1792, 1
        return {
            "x": _w((lambda *s: torch.randn(*s, dtype=torch.bfloat16) * 0.05)(B, S, D)),
            "w_r": _w((lambda *s: torch.randn(*s, dtype=torch.bfloat16) * 0.05)(D)),
            "w_gate": _w((lambda *s: torch.randn(*s, dtype=torch.bfloat16) * 0.05)(D, F)),
            "w_up": _w((lambda *s: torch.randn(*s, dtype=torch.bfloat16) * 0.05)(D, F)),
            "w_down": _w((lambda *s: torch.randn(*s, dtype=torch.bfloat16) * 0.05)(F, D)),
        }
    _B_in = _B_setup()

    return {
        "A_x": _A_in["x"],
        "A_wqkv": _A_in["wqkv"],
        "A_wo": _A_in["wo"],
        "B_x": _B_in["x"],
        "B_w_r": _B_in["w_r"],
        "B_w_gate": _B_in["w_gate"],
        "B_w_up": _B_in["w_up"],
        "B_w_down": _B_in["w_down"],
    }

def reference(A_x, A_wqkv, A_wo, B_x, B_w_r, B_w_gate, B_w_up, B_w_down):
    def _A_ref(x, wqkv, wo):
        B, S, D = x.shape
        H = 16
        Dh = D // H
        qkv = (lambda x, *d: x.permute(*d))((x @ wqkv).reshape(B, S, 3, H, Dh), 2, 0, 3, 1, 4)
        q, k, v = qkv[0], qkv[1], qkv[2]
        scores = torch.einsum("bhqd,bhkd->bhqk", q, k) * (Dh ** -0.5)
        p = _softmax(scores, axis=-1)
        o = torch.einsum("bhqk,bhkd->bhqd", p, v)
        return (lambda x, *d: x.permute(*d))(o, 0, 2, 1, 3).reshape(B, S, D) @ wo

    def _B_ref(x, w_r, w_gate, w_up, w_down):
        B, S, D = x.shape
        C = 1
        r = x @ w_r
        idx = torch.argsort(-r, axis=-1)[:, :C]
        idx_e = (lambda x, n, axis: torch.repeat_interleave(x, n, dim=axis))(idx.reshape(B, C, 1), D, axis=2)
        x_sel = (lambda x, i, axis: torch.take_along_dim(x, i, dim=axis))(x, idx_e, axis=1)
        g = _silu(x_sel @ w_gate)
        u = x_sel @ w_up
        y = (g * u) @ w_down
        r_sel = _sigmoid((lambda x, i, axis: torch.take_along_dim(x, i, dim=axis))(r, idx, axis=1))
        y = y * r_sel.reshape(B, C, 1)
        b_off = (torch.arange(B) * S).reshape(B, 1)
        flat_idx = (idx + b_off).reshape(B * C)
        zero = (x * 0.0).reshape(B * S, D)
        upd = _scatter_add(zero, flat_idx, y.reshape(B * C, D), axis=0)
        return x + upd.reshape(B, S, D)

    x = A_x
    xn = _layernorm(x, axis=-1)
    s = _A_ref(xn, A_wqkv, A_wo)
    g = _silu(_B_ref(xn, B_w_r, B_w_gate, B_w_up, B_w_down))
    return x + s * g
```

```asm
; @launch kernel=recurrent_scan__mha_block__moe_arch_mod__prompt_kernel grid=(960,1,1) block=(256,1,1) lds=0
; @launch kernel=k1_qkv_kernel grid=(248,1,1) block=(256,1,1) lds=20480
; @launch kernel=k2_attn_kernel grid=(513,1,1) block=(256,1,1) lds=36864
; @launch kernel=k3_out_kernel grid=(224,1,1) block=(256,1,1) lds=0
.amdgcn_target "amdgcn-amd-amdhsa--gfx950"
.text
.globl recurrent_scan__mha_block__moe_arch_mod__prompt_kernel
.p2align 8
.type recurrent_scan__mha_block__moe_arch_mod__prompt_kernel,@function
recurrent_scan__mha_block__moe_arch_mod__prompt_kernel:
  s_cmp_ge_u32 s2, 960
  s_cbranch_scc1 K0_end
  s_load_dwordx2 s[4:5], s[0:1], 0
  s_load_dwordx2 s[6:7], s[0:1], 8
  s_load_dwordx2 s[8:9], s[0:1], 16
  s_load_dwordx2 s[10:11], s[0:1], 32
  s_load_dwordx2 s[12:13], s[0:1], 80
  v_lshrrev_b32 v1, 6, v0
  v_and_b32 v2, 63, v0
  s_nop 1
  v_readfirstlane_b32 s14, v1
  s_lshl_b32 s15, s2, 2
  s_add_u32 s15, s15, s14
  v_and_b32 v40, 31, v2
  v_lshrrev_b32 v41, 5, v2
  v_lshlrev_b32 v42, 4, v2
  s_waitcnt lgkmcnt(0)
  s_cmp_lt_u32 s15, 2048
  s_cbranch_scc1 K0_ln
  s_cmp_lt_u32 s15, 3392
  s_cbranch_scc1 K0_wf
  s_branch K0_wof
K0_ln:
  s_mul_i32 s16, s15, 896
  v_add_u32 v3, s16, v42
  v_mov_b32 v4, 0
  v_mov_b32 v5, 0
  v_mov_b32 v6, 0
  v_mov_b32 v7, 0
  v_mov_b32 v8, 0
  v_mov_b32 v9, 0
  v_mov_b32 v10, 0
  v_mov_b32 v11, 0
  v_mov_b32 v20, 0
  v_mov_b32 v22, 0
  v_mov_b32 v23, 0
  s_mov_b32 exec_lo, -1
  s_mov_b32 exec_hi, 0x00ffffff
  global_load_dwordx4 v[4:7], v3, s[4:5]
  global_load_dwordx4 v[8:11], v42, s[10:11]
  s_waitcnt vmcnt(1)
  v_lshlrev_b32 v12, 16, v4
  v_and_b32 v13, 0xffff0000, v4
  v_lshlrev_b32 v14, 16, v5
  v_and_b32 v15, 0xffff0000, v5
  v_lshlrev_b32 v16, 16, v6
  v_and_b32 v17, 0xffff0000, v6
  v_lshlrev_b32 v18, 16, v7
  v_and_b32 v19, 0xffff0000, v7
  v_add_f32 v20, v12, v13
  v_add_f32 v21, v14, v15
  v_add_f32 v24, v16, v17
  v_add_f32 v25, v18, v19
  v_add_f32 v20, v20, v21
  v_add_f32 v24, v24, v25
  v_add_f32 v20, v20, v24
  s_mov_b64 exec, -1
  s_nop 1
  v_add_f32_dpp v20, v20, v20 row_shr:1 row_mask:0xf bank_mask:0xf bound_ctrl:0
  s_nop 1
  v_add_f32_dpp v20, v20, v20 row_shr:2 row_mask:0xf bank_mask:0xf bound_ctrl:0
  s_nop 1
  v_add_f32_dpp v20, v20, v20 row_shr:4 row_mask:0xf bank_mask:0xf bound_ctrl:0
  s_nop 1
  v_add_f32_dpp v20, v20, v20 row_shr:8 row_mask:0xf bank_mask:0xf bound_ctrl:0
  s_nop 1
  v_add_f32_dpp v20, v20, v20 row_bcast:15 row_mask:0xa bank_mask:0xf bound_ctrl:0
  s_nop 1
  v_add_f32_dpp v20, v20, v20 row_bcast:31 row_mask:0xc bank_mask:0xf bound_ctrl:0
  s_nop 1
  v_readlane_b32 s17, v20, 63
  v_mov_b32 v26, 0x3b124925
  s_nop 0
  v_mul_f32 v27, s17, v26
  s_mov_b32 exec_hi, 0x00ffffff
  v_sub_f32 v24, v12, v27
  v_fmac_f32 v22, v24, v24
  v_sub_f32 v24, v13, v27
  v_fmac_f32 v22, v24, v24
  v_sub_f32 v24, v14, v27
  v_fmac_f32 v22, v24, v24
  v_sub_f32 v24, v15, v27
  v_fmac_f32 v22, v24, v24
  v_sub_f32 v24, v16, v27
  v_fmac_f32 v22, v24, v24
  v_sub_f32 v24, v17, v27
  v_fmac_f32 v22, v24, v24
  v_sub_f32 v24, v18, v27
  v_fmac_f32 v22, v24, v24
  v_sub_f32 v24, v19, v27
  v_fmac_f32 v22, v24, v24
  s_mov_b64 exec, -1
  s_nop 1
  v_add_f32_dpp v22, v22, v22 row_shr:1 row_mask:0xf bank_mask:0xf bound_ctrl:0
  s_nop 1
  v_add_f32_dpp v22, v22, v22 row_shr:2 row_mask:0xf bank_mask:0xf bound_ctrl:0
  s_nop 1
  v_add_f32_dpp v22, v22, v22 row_shr:4 row_mask:0xf bank_mask:0xf bound_ctrl:0
  s_nop 1
  v_add_f32_dpp v22, v22, v22 row_shr:8 row_mask:0xf bank_mask:0xf bound_ctrl:0
  s_nop 1
  v_add_f32_dpp v22, v22, v22 row_bcast:15 row_mask:0xa bank_mask:0xf bound_ctrl:0
  s_nop 1
  v_add_f32_dpp v22, v22, v22 row_bcast:31 row_mask:0xc bank_mask:0xf bound_ctrl:0
  s_nop 1
  v_readlane_b32 s18, v22, 63
  s_nop 0
  v_mul_f32 v28, s18, v26
  v_cvt_pk_bf16_f32 v24, v28, v28
  v_lshlrev_b32 v28, 16, v24
  v_add_f32 v28, 0x3727c5ac, v28
  v_cvt_pk_bf16_f32 v24, v28, v28
  v_lshlrev_b32 v28, 16, v24
  v_sqrt_f32 v28, v28
  s_nop 0
  v_cvt_pk_bf16_f32 v24, v28, v28
  v_lshlrev_b32 v28, 16, v24
  v_cvt_pk_bf16_f32 v24, v27, v27
  v_lshlrev_b32 v27, 16, v24
  v_rcp_f32 v29, v28
  s_nop 0
  v_sub_f32 v24, v12, v27
  v_sub_f32 v25, v13, v27
  v_cvt_pk_bf16_f32 v30, v24, v25
  v_lshlrev_b32 v24, 16, v30
  v_and_b32 v25, 0xffff0000, v30
  v_mul_f32 v31, v24, v29
  v_mul_f32 v32, v25, v29
  v_fma_f32 v33, -v31, v28, v24
  v_fma_f32 v34, -v32, v28, v25
  v_fma_f32 v31, v33, v29, v31
  v_fma_f32 v32, v34, v29, v32
  v_cvt_pk_bf16_f32 v44, v31, v32
  v_sub_f32 v24, v14, v27
  v_sub_f32 v25, v15, v27
  v_cvt_pk_bf16_f32 v30, v24, v25
  v_lshlrev_b32 v24, 16, v30
  v_and_b32 v25, 0xffff0000, v30
  v_mul_f32 v31, v24, v29
  v_mul_f32 v32, v25, v29
  v_fma_f32 v33, -v31, v28, v24
  v_fma_f32 v34, -v32, v28, v25
  v_fma_f32 v31, v33, v29, v31
  v_fma_f32 v32, v34, v29, v32
  v_cvt_pk_bf16_f32 v45, v31, v32
  v_sub_f32 v24, v16, v27
  v_sub_f32 v25, v17, v27
  v_cvt_pk_bf16_f32 v30, v24, v25
  v_lshlrev_b32 v24, 16, v30
  v_and_b32 v25, 0xffff0000, v30
  v_mul_f32 v31, v24, v29
  v_mul_f32 v32, v25, v29
  v_fma_f32 v33, -v31, v28, v24
  v_fma_f32 v34, -v32, v28, v25
  v_fma_f32 v31, v33, v29, v31
  v_fma_f32 v32, v34, v29, v32
  v_cvt_pk_bf16_f32 v46, v31, v32
  v_sub_f32 v24, v18, v27
  v_sub_f32 v25, v19, v27
  v_cvt_pk_bf16_f32 v30, v24, v25
  v_lshlrev_b32 v24, 16, v30
  v_and_b32 v25, 0xffff0000, v30
  v_mul_f32 v31, v24, v29
  v_mul_f32 v32, v25, v29
  v_fma_f32 v33, -v31, v28, v24
  v_fma_f32 v34, -v32, v28, v25
  v_fma_f32 v31, v33, v29, v31
  v_fma_f32 v32, v34, v29, v32
  v_cvt_pk_bf16_f32 v47, v31, v32
  s_waitcnt vmcnt(0)
  s_mov_b32 exec_hi, 0x00ffffff
  v_lshlrev_b32 v24, 16, v44
  v_and_b32 v25, 0xffff0000, v44
  v_lshlrev_b32 v31, 16, v8
  v_and_b32 v32, 0xffff0000, v8
  v_fmac_f32 v23, v24, v31
  v_fmac_f32 v23, v25, v32
  v_lshlrev_b32 v24, 16, v45
  v_and_b32 v25, 0xffff0000, v45
  v_lshlrev_b32 v31, 16, v9
  v_and_b32 v32, 0xffff0000, v9
  v_fmac_f32 v23, v24, v31
  v_fmac_f32 v23, v25, v32
  v_lshlrev_b32 v24, 16, v46
  v_and_b32 v25, 0xffff0000, v46
  v_lshlrev_b32 v31, 16, v10
  v_and_b32 v32, 0xffff0000, v10
  v_fmac_f32 v23, v24, v31
  v_fmac_f32 v23, v25, v32
  v_lshlrev_b32 v24, 16, v47
  v_and_b32 v25, 0xffff0000, v47
  v_lshlrev_b32 v31, 16, v11
  v_and_b32 v32, 0xffff0000, v11
  v_fmac_f32 v23, v24, v31
  v_fmac_f32 v23, v25, v32
  s_add_u32 s20, s12, 1835008
  s_addc_u32 s21, s13, 0
  global_store_dwordx4 v3, v[44:47], s[20:21]
  s_lshr_b32 s22, s15, 5
  s_mul_i32 s22, s22, 28672
  s_and_b32 s23, s15, 31
  s_lshl_b32 s23, s23, 4
  s_add_u32 s22, s22, s23
  v_lshrrev_b32 v24, 1, v2
  v_lshlrev_b32 v24, 10, v24
  v_and_b32 v25, 1, v2
  v_lshlrev_b32 v25, 9, v25
  v_add3_u32 v24, v24, v25, s22
  s_add_u32 s20, s12, 0
  s_addc_u32 s21, s13, 0
  global_store_dwordx4 v24, v[44:47], s[20:21]
  s_mov_b64 exec, -1
  s_nop 1
  v_add_f32_dpp v23, v23, v23 row_shr:1 row_mask:0xf bank_mask:0xf bound_ctrl:0
  s_nop 1
  v_add_f32_dpp v23, v23, v23 row_shr:2 row_mask:0xf bank_mask:0xf bound_ctrl:0
  s_nop 1
  v_add_f32_dpp v23, v23, v23 row_shr:4 row_mask:0xf bank_mask:0xf bound_ctrl:0
  s_nop 1
  v_add_f32_dpp v23, v23, v23 row_shr:8 row_mask:0xf bank_mask:0xf bound_ctrl:0
  s_nop 1
  v_add_f32_dpp v23, v23, v23 row_bcast:15 row_mask:0xa bank_mask:0xf bound_ctrl:0
  s_nop 1
  v_add_f32_dpp v23, v23, v23 row_bcast:31 row_mask:0xc bank_mask:0xf bound_ctrl:0
  s_nop 1
  v_readlane_b32 s19, v23, 63
  s_lshl_b32 s22, s15, 2
  v_mov_b32 v24, s19
  v_mov_b32 v25, s22
  s_add_u32 s20, s12, 3670016
  s_addc_u32 s21, s13, 0
  s_mov_b64 exec, 1
  global_store_dword v25, v24, s[20:21]
  s_branch K0_end
K0_wf:
  s_sub_u32 s16, s15, 2048
  s_mov_b32 s17, 153391690
  s_mul_hi_u32 s17, s16, s17
  s_mul_i32 s18, s17, 28
  s_sub_u32 s18, s16, s18
  s_lshr_b32 s19, s17, 4
  s_and_b32 s20, s17, 15
  s_mul_i32 s19, s19, 448
  s_mul_i32 s20, s20, 28
  s_add_u32 s19, s19, s20
  s_lshl_b32 s19, s19, 1
  s_mul_i32 s20, s18, 43008
  s_add_u32 s19, s19, s20
  v_mul_u32_u24 v3, 21504, v41
  v_lshl_add_u32 v3, v40, 1, v3
  s_add_u32 s24, s6, s19
  s_addc_u32 s25, s7, 0
  s_add_u32 s19, s19, 2688
  s_add_u32 s26, s6, s19
  s_addc_u32 s27, s7, 0
  s_add_u32 s19, s19, 2688
  s_add_u32 s28, s6, s19
  s_addc_u32 s29, s7, 0
  s_add_u32 s19, s19, 2688
  s_add_u32 s30, s6, s19
  s_addc_u32 s31, s7, 0
  s_add_u32 s19, s19, 2688
  s_add_u32 s32, s6, s19
  s_addc_u32 s33, s7, 0
  s_add_u32 s19, s19, 2688
  s_add_u32 s34, s6, s19
  s_addc_u32 s35, s7, 0
  s_add_u32 s19, s19, 2688
  s_add_u32 s36, s6, s19
  s_addc_u32 s37, s7, 0
  s_add_u32 s19, s19, 2688
  s_add_u32 s38, s6, s19
  s_addc_u32 s39, s7, 0
  v_mov_b32 v4, 0
  v_mov_b32 v5, 0
  v_mov_b32 v6, 0
  v_mov_b32 v7, 0
  v_mov_b32 v8, 0
  v_mov_b32 v9, 0
  v_mov_b32 v10, 0
  v_mov_b32 v11, 0
  v_cmp_gt_u32 vcc, 28, v40
  s_and_saveexec_b64 s[22:23], vcc
  global_load_ushort v4, v3, s[24:25]
  global_load_ushort v5, v3, s[26:27]
  global_load_ushort v6, v3, s[28:29]
  global_load_ushort v7, v3, s[30:31]
  global_load_ushort v8, v3, s[32:33]
  global_load_ushort v9, v3, s[34:35]
  global_load_ushort v10, v3, s[36:37]
  global_load_ushort v11, v3, s[38:39]
  s_mov_b64 exec, s[22:23]
  s_lshl_b32 s16, s16, 10
  s_add_u32 s16, s16, 3735552
  s_add_u32 s20, s12, s16
  s_addc_u32 s21, s13, 0
  s_waitcnt vmcnt(0)
  v_lshl_or_b32 v12, v5, 16, v4
  v_lshl_or_b32 v13, v7, 16, v6
  v_lshl_or_b32 v14, v9, 16, v8
  v_lshl_or_b32 v15, v11, 16, v10
  global_store_dwordx4 v42, v[12:15], s[20:21]
  s_branch K0_end
K0_wof:
  s_sub_u32 s16, s15, 3392
  s_lshr_b32 s17, s16, 5
  s_and_b32 s18, s16, 31
  s_lshr_b32 s19, s18, 1
  s_and_b32 s20, s18, 1
  s_mul_i32 s19, s19, 25088
  s_lshl_b32 s17, s17, 6
  s_add_u32 s19, s19, s17
  v_mul_u32_u24 v3, 3584, v41
  v_lshl_add_u32 v3, v40, 1, v3
  v_lshlrev_b32 v5, 2, v41
  s_mul_i32 s21, s20, 16
  v_mov_b32 v12, 0
  v_mov_b32 v13, 0
  v_mov_b32 v14, 0
  v_mov_b32 v15, 0
  v_mov_b32 v16, 0
  v_mov_b32 v17, 0
  v_mov_b32 v18, 0
  v_mov_b32 v19, 0
  s_add_u32 s22, s21, 0
  s_mul_i32 s23, s22, 896
  s_add_u32 s23, s23, s19
  s_add_u32 s24, s8, s23
  s_addc_u32 s25, s9, 0
  s_sub_u32 s22, 28, s22
  v_cmp_gt_u32 vcc, s22, v5
  s_and_saveexec_b64 s[26:27], vcc
  global_load_ushort v12, v3, s[24:25]
  s_mov_b64 exec, s[26:27]
  s_add_u32 s22, s21, 1
  s_mul_i32 s23, s22, 896
  s_add_u32 s23, s23, s19
  s_add_u32 s24, s8, s23
  s_addc_u32 s25, s9, 0
  s_sub_u32 s22, 28, s22
  v_cmp_gt_u32 vcc, s22, v5
  s_and_saveexec_b64 s[26:27], vcc
  global_load_ushort v13, v3, s[24:25]
  s_mov_b64 exec, s[26:27]
  s_add_u32 s22, s21, 2
  s_mul_i32 s23, s22, 896
  s_add_u32 s23, s23, s19
  s_add_u32 s24, s8, s23
  s_addc_u32 s25, s9, 0
  s_sub_u32 s22, 28, s22
  v_cmp_gt_u32 vcc, s22, v5
  s_and_saveexec_b64 s[26:27], vcc
  global_load_ushort v14, v3, s[24:25]
  s_mov_b64 exec, s[26:27]
  s_add_u32 s22, s21, 3
  s_mul_i32 s23, s22, 896
  s_add_u32 s23, s23, s19
  s_add_u32 s24, s8, s23
  s_addc_u32 s25, s9, 0
  s_sub_u32 s22, 28, s22
  v_cmp_gt_u32 vcc, s22, v5
  s_and_saveexec_b64 s[26:27], vcc
  global_load_ushort v15, v3, s[24:25]
  s_mov_b64 exec, s[26:27]
  s_add_u32 s22, s21, 8
  s_mul_i32 s23, s22, 896
  s_add_u32 s23, s23, s19
  s_add_u32 s24, s8, s23
  s_addc_u32 s25, s9, 0
  s_sub_u32 s22, 28, s22
  v_cmp_gt_u32 vcc, s22, v5
  s_and_saveexec_b64 s[26:27], vcc
  global_load_ushort v16, v3, s[24:25]
  s_mov_b64 exec, s[26:27]
  s_add_u32 s22, s21, 9
  s_mul_i32 s23, s22, 896
  s_add_u32 s23, s23, s19
  s_add_u32 s24, s8, s23
  s_addc_u32 s25, s9, 0
  s_sub_u32 s22, 28, s22
  v_cmp_gt_u32 vcc, s22, v5
  s_and_saveexec_b64 s[26:27], vcc
  global_load_ushort v17, v3, s[24:25]
  s_mov_b64 exec, s[26:27]
  s_add_u32 s22, s21, 10
  s_mul_i32 s23, s22, 896
  s_add_u32 s23, s23, s19
  s_add_u32 s24, s8, s23
  s_addc_u32 s25, s9, 0
  s_sub_u32 s22, 28, s22
  v_cmp_gt_u32 vcc, s22, v5
  s_and_saveexec_b64 s[26:27], vcc
  global_load_ushort v18, v3, s[24:25]
  s_mov_b64 exec, s[26:27]
  s_add_u32 s22, s21, 11
  s_mul_i32 s23, s22, 896
  s_add_u32 s23, s23, s19
  s_add_u32 s24, s8, s23
  s_addc_u32 s25, s9, 0
  s_sub_u32 s22, 28, s22
  v_cmp_gt_u32 vcc, s22, v5
  s_and_saveexec_b64 s[26:27], vcc
  global_load_ushort v19, v3, s[24:25]
  s_mov_b64 exec, s[26:27]
  s_lshl_b32 s16, s16, 10
  s_add_u32 s16, s16, 5111808
  s_add_u32 s20, s12, s16
  s_addc_u32 s21, s13, 0
  s_waitcnt vmcnt(0)
  v_lshl_or_b32 v24, v13, 16, v12
  v_lshl_or_b32 v25, v15, 16, v14
  v_lshl_or_b32 v26, v17, 16, v16
  v_lshl_or_b32 v27, v19, 16, v18
  global_store_dwordx4 v42, v[24:27], s[20:21]
K0_end:
  s_endpgm
.globl k1_qkv_kernel
.p2align 8
.type k1_qkv_kernel,@function
k1_qkv_kernel:
  s_cmp_ge_u32 s2, 248
  s_cbranch_scc1 K1_end
  s_load_dwordx2 s[12:13], s[0:1], 80
  v_lshrrev_b32 v1, 6, v0
  v_and_b32 v2, 63, v0
  v_lshlrev_b32 v3, 4, v2
  v_readfirstlane_b32 s14, v1
  s_cmp_ge_u32 s2, 192
  s_cbranch_scc1 K1_ffn
  s_lshl_b32 s15, s2, 2
  s_add_u32 s15, s15, s14
  s_mov_b32 s16, 178956971
  s_mul_hi_u32 s16, s15, s16
  s_mul_i32 s17, s16, 24
  s_sub_u32 s17, s15, s17
  s_waitcnt lgkmcnt(0)
  s_mul_i32 s18, s16, 57344
  s_add_u32 s18, s18, 0
  s_add_u32 s20, s12, s18
  s_addc_u32 s21, s13, 0
  s_add_u32 s18, s18, 28672
  s_add_u32 s22, s12, s18
  s_addc_u32 s23, s13, 0
  s_mul_i32 s18, s17, 57344
  s_add_u32 s18, s18, 3735552
  s_add_u32 s24, s12, s18
  s_addc_u32 s25, s13, 0
  s_add_u32 s18, s18, 28672
  s_add_u32 s26, s12, s18
  s_addc_u32 s27, s13, 0
  s_lshr_b32 s28, s17, 3
  s_and_b32 s29, s17, 7
  s_lshl_b32 s29, s29, 1
  s_lshl_b32 s30, s16, 1
  s_lshl_b32 s31, s29, 6
  s_add_u32 s31, s31, s30
  s_lshl_b32 s31, s31, 11
  s_cmp_eq_u32 s28, 2
  s_cbranch_scc1 K1_vpath
  global_load_dwordx4 v[128:131], v3, s[20:21] offset:0
  global_load_dwordx4 v[132:135], v3, s[22:23] offset:0
  global_load_dwordx4 v[136:139], v3, s[24:25] offset:0
  global_load_dwordx4 v[140:143], v3, s[26:27] offset:0
  global_load_dwordx4 v[144:147], v3, s[20:21] offset:1024
  global_load_dwordx4 v[148:151], v3, s[22:23] offset:1024
  global_load_dwordx4 v[152:155], v3, s[24:25] offset:1024
  global_load_dwordx4 v[156:159], v3, s[26:27] offset:1024
  global_load_dwordx4 v[160:163], v3, s[20:21] offset:2048
  global_load_dwordx4 v[164:167], v3, s[22:23] offset:2048
  global_load_dwordx4 v[168:171], v3, s[24:25] offset:2048
  global_load_dwordx4 v[172:175], v3, s[26:27] offset:2048
  global_load_dwordx4 v[176:179], v3, s[20:21] offset:3072
  global_load_dwordx4 v[180:183], v3, s[22:23] offset:3072
  global_load_dwordx4 v[184:187], v3, s[24:25] offset:3072
  global_load_dwordx4 v[188:191], v3, s[26:27] offset:3072
  s_add_u32 s20, s20, 4096
  s_addc_u32 s21, s21, 0
  s_add_u32 s22, s22, 4096
  s_addc_u32 s23, s23, 0
  s_add_u32 s24, s24, 4096
  s_addc_u32 s25, s25, 0
  s_add_u32 s26, s26, 4096
  s_addc_u32 s27, s27, 0
  global_load_dwordx4 v[192:195], v3, s[20:21] offset:0
  global_load_dwordx4 v[196:199], v3, s[22:23] offset:0
  global_load_dwordx4 v[200:203], v3, s[24:25] offset:0
  global_load_dwordx4 v[204:207], v3, s[26:27] offset:0
  global_load_dwordx4 v[208:211], v3, s[20:21] offset:1024
  global_load_dwordx4 v[212:215], v3, s[22:23] offset:1024
  global_load_dwordx4 v[216:219], v3, s[24:25] offset:1024
  global_load_dwordx4 v[220:223], v3, s[26:27] offset:1024
  global_load_dwordx4 v[224:227], v3, s[20:21] offset:2048
  global_load_dwordx4 v[228:231], v3, s[22:23] offset:2048
  global_load_dwordx4 v[232:235], v3, s[24:25] offset:2048
  global_load_dwordx4 v[236:239], v3, s[26:27] offset:2048
  global_load_dwordx4 v[240:243], v3, s[20:21] offset:3072
  global_load_dwordx4 v[244:247], v3, s[22:23] offset:3072
  global_load_dwordx4 v[248:251], v3, s[24:25] offset:3072
  global_load_dwordx4 v[252:255], v3, s[26:27] offset:3072
  s_waitcnt vmcnt(28)
  v_mfma_f32_32x32x16_bf16 v[64:79], v[136:139], v[128:131], 0
  v_mfma_f32_32x32x16_bf16 v[80:95], v[140:143], v[128:131], 0
  v_mfma_f32_32x32x16_bf16 v[96:111], v[136:139], v[132:135], 0
  v_mfma_f32_32x32x16_bf16 v[112:127], v[140:143], v[132:135], 0
  s_add_u32 s20, s20, 4096
  s_addc_u32 s21, s21, 0
  s_add_u32 s22, s22, 4096
  s_addc_u32 s23, s23, 0
  s_add_u32 s24, s24, 4096
  s_addc_u32 s25, s25, 0
  s_add_u32 s26, s26, 4096
  s_addc_u32 s27, s27, 0
  global_load_dwordx4 v[128:131], v3, s[20:21] offset:0
  global_load_dwordx4 v[132:135], v3, s[22:23] offset:0
  global_load_dwordx4 v[136:139], v3, s[24:25] offset:0
  global_load_dwordx4 v[140:143], v3, s[26:27] offset:0
  s_waitcnt vmcnt(28)
  v_mfma_f32_32x32x16_bf16 v[64:79], v[152:155], v[144:147], v[64:79]
  v_mfma_f32_32x32x16_bf16 v[80:95], v[156:159], v[144:147], v[80:95]
  v_mfma_f32_32x32x16_bf16 v[96:111], v[152:155], v[148:151], v[96:111]
  v_mfma_f32_32x32x16_bf16 v[112:127], v[156:159], v[148:151], v[112:127]
  global_load_dwordx4 v[144:147], v3, s[20:21] offset:1024
  global_load_dwordx4 v[148:151], v3, s[22:23] offset:1024
  global_load_dwordx4 v[152:155], v3, s[24:25] offset:1024
  global_load_dwordx4 v[156:159], v3, s[26:27] offset:1024
  s_waitcnt vmcnt(28)
  v_mfma_f32_32x32x16_bf16 v[64:79], v[168:171], v[160:163], v[64:79]
  v_mfma_f32_32x32x16_bf16 v[80:95], v[172:175], v[160:163], v[80:95]
  v_mfma_f32_32x32x16_bf16 v[96:111], v[168:171], v[164:167], v[96:111]
  v_mfma_f32_32x32x16_bf16 v[112:127], v[172:175], v[164:167], v[112:127]
  global_load_dwordx4 v[160:163], v3, s[20:21] offset:2048
  global_load_dwordx4 v[164:167], v3, s[22:23] offset:2048
  global_load_dwordx4 v[168:171], v3, s[24:25] offset:2048
  global_load_dwordx4 v[172:175], v3, s[26:27] offset:2048
  s_waitcnt vmcnt(28)
  v_mfma_f32_32x32x16_bf16 v[64:79], v[184:187], v[176:179], v[64:79]
  v_mfma_f32_32x32x16_bf16 v[80:95], v[188:191], v[176:179], v[80:95]
  v_mfma_f32_32x32x16_bf16 v[96:111], v[184:187], v[180:183], v[96:111]
  v_mfma_f32_32x32x16_bf16 v[112:127], v[188:191], v[180:183], v[112:127]
  global_load_dwordx4 v[176:179], v3, s[20:21] offset:3072
  global_load_dwordx4 v[180:183], v3, s[22:23] offset:3072
  global_load_dwordx4 v[184:187], v3, s[24:25] offset:3072
  global_load_dwordx4 v[188:191], v3, s[26:27] offset:3072
  s_waitcnt vmcnt(28)
  v_mfma_f32_32x32x16_bf16 v[64:79], v[200:203], v[192:195], v[64:79]
  v_mfma_f32_32x32x16_bf16 v[80:95], v[204:207], v[192:195], v[80:95]
  v_mfma_f32_32x32x16_bf16 v[96:111], v[200:203], v[196:199], v[96:111]
  v_mfma_f32_32x32x16_bf16 v[112:127], v[204:207], v[196:199], v[112:127]
  s_add_u32 s20, s20, 4096
  s_addc_u32 s21, s21, 0
  s_add_u32 s22, s22, 4096
  s_addc_u32 s23, s23, 0
  s_add_u32 s24, s24, 4096
  s_addc_u32 s25, s25, 0
  s_add_u32 s26, s26, 4096
  s_addc_u32 s27, s27, 0
  global_load_dwordx4 v[192:195], v3, s[20:21] offset:0
  global_load_dwordx4 v[196:199], v3, s[22:23] offset:0
  global_load_dwordx4 v[200:203], v3, s[24:25] offset:0
  global_load_dwordx4 v[204:207], v3, s[26:27] offset:0
  s_waitcnt vmcnt(28)
  v_mfma_f32_32x32x16_bf16 v[64:79], v[216:219], v[208:211], v[64:79]
  v_mfma_f32_32x32x16_bf16 v[80:95], v[220:223], v[208:211], v[80:95]
  v_mfma_f32_32x32x16_bf16 v[96:111], v[216:219], v[212:215], v[96:111]
  v_mfma_f32_32x32x16_bf16 v[112:127], v[220:223], v[212:215], v[112:127]
  global_load_dwordx4 v[208:211], v3, s[20:21] offset:1024
  global_load_dwordx4 v[212:215], v3, s[22:23] offset:1024
  global_load_dwordx4 v[216:219], v3, s[24:25] offset:1024
  global_load_dwordx4 v[220:223], v3, s[26:27] offset:1024
  s_waitcnt vmcnt(28)
  v_mfma_f32_32x32x16_bf16 v[64:79], v[232:235], v[224:227], v[64:79]
  v_mfma_f32_32x32x16_bf16 v[80:95], v[236:239], v[224:227], v[80:95]
  v_mfma_f32_32x32x16_bf16 v[96:111], v[232:235], v[228:231], v[96:111]
  v_mfma_f32_32x32x16_bf16 v[112:127], v[236:239], v[228:231], v[112:127]
  global_load_dwordx4 v[224:227], v3, s[20:21] offset:2048
  global_load_dwordx4 v[228:231], v3, s[22:23] offset:2048
  global_load_dwordx4 v[232:235], v3, s[24:25] offset:2048
  global_load_dwordx4 v[236:239], v3, s[26:27] offset:2048
  s_waitcnt vmcnt(28)
  v_mfma_f32_32x32x16_bf16 v[64:79], v[248:251], v[240:243], v[64:79]
  v_mfma_f32_32x32x16_bf16 v[80:95], v[252:255], v[240:243], v[80:95]
  v_mfma_f32_32x32x16_bf16 v[96:111], v[248:251], v[244:247], v[96:111]
  v_mfma_f32_32x32x16_bf16 v[112:127], v[252:255], v[244:247], v[112:127]
  global_load_dwordx4 v[240:243], v3, s[20:21] offset:3072
  global_load_dwordx4 v[244:247], v3, s[22:23] offset:3072
  global_load_dwordx4 v[248:251], v3, s[24:25] offset:3072
  global_load_dwordx4 v[252:255], v3, s[26:27] offset:3072
  s_waitcnt vmcnt(28)
  v_mfma_f32_32x32x16_bf16 v[64:79], v[136:139], v[128:131], v[64:79]
  v_mfma_f32_32x32x16_bf16 v[80:95], v[140:143], v[128:131], v[80:95]
  v_mfma_f32_32x32x16_bf16 v[96:111], v[136:139], v[132:135], v[96:111]
  v_mfma_f32_32x32x16_bf16 v[112:127], v[140:143], v[132:135], v[112:127]
  s_add_u32 s20, s20, 4096
  s_addc_u32 s21, s21, 0
  s_add_u32 s22, s22, 4096
  s_addc_u32 s23, s23, 0
  s_add_u32 s24, s24, 4096
  s_addc_u32 s25, s25, 0
  s_add_u32 s26, s26, 4096
  s_addc_u32 s27, s27, 0
  global_load_dwordx4 v[128:131], v3, s[20:21] offset:0
  global_load_dwordx4 v[132:135], v3, s[22:23] offset:0
  global_load_dwordx4 v[136:139], v3, s[24:25] offset:0
  global_load_dwordx4 v[140:143], v3, s[26:27] offset:0
  s_waitcnt vmcnt(28)
  v_mfma_f32_32x32x16_bf16 v[64:79], v[152:155], v[144:147], v[64:79]
  v_mfma_f32_32x32x16_bf16 v[80:95], v[156:159], v[144:147], v[80:95]
  v_mfma_f32_32x32x16_bf16 v[96:111], v[152:155], v[148:151], v[96:111]
  v_mfma_f32_32x32x16_bf16 v[112:127], v[156:159], v[148:151], v[112:127]
  global_load_dwordx4 v[144:147], v3, s[20:21] offset:1024
  global_load_dwordx4 v[148:151], v3, s[22:23] offset:1024
  global_load_dwordx4 v[152:155], v3, s[24:25] offset:1024
  global_load_dwordx4 v[156:159], v3, s[26:27] offset:1024
  s_waitcnt vmcnt(28)
  v_mfma_f32_32x32x16_bf16 v[64:79], v[168:171], v[160:163], v[64:79]
  v_mfma_f32_32x32x16_bf16 v[80:95], v[172:175], v[160:163], v[80:95]
  v_mfma_f32_32x32x16_bf16 v[96:111], v[168:171], v[164:167], v[96:111]
  v_mfma_f32_32x32x16_bf16 v[112:127], v[172:175], v[164:167], v[112:127]
  global_load_dwordx4 v[160:163], v3, s[20:21] offset:2048
  global_load_dwordx4 v[164:167], v3, s[22:23] offset:2048
  global_load_dwordx4 v[168:171], v3, s[24:25] offset:2048
  global_load_dwordx4 v[172:175], v3, s[26:27] offset:2048
  s_waitcnt vmcnt(28)
  v_mfma_f32_32x32x16_bf16 v[64:79], v[184:187], v[176:179], v[64:79]
  v_mfma_f32_32x32x16_bf16 v[80:95], v[188:191], v[176:179], v[80:95]
  v_mfma_f32_32x32x16_bf16 v[96:111], v[184:187], v[180:183], v[96:111]
  v_mfma_f32_32x32x16_bf16 v[112:127], v[188:191], v[180:183], v[112:127]
  global_load_dwordx4 v[176:179], v3, s[20:21] offset:3072
  global_load_dwordx4 v[180:183], v3, s[22:23] offset:3072
  global_load_dwordx4 v[184:187], v3, s[24:25] offset:3072
  global_load_dwordx4 v[188:191], v3, s[26:27] offset:3072
  s_waitcnt vmcnt(28)
  v_mfma_f32_32x32x16_bf16 v[64:79], v[200:203], v[192:195], v[64:79]
  v_mfma_f32_32x32x16_bf16 v[80:95], v[204:207], v[192:195], v[80:95]
  v_mfma_f32_32x32x16_bf16 v[96:111], v[200:203], v[196:199], v[96:111]
  v_mfma_f32_32x32x16_bf16 v[112:127], v[204:207], v[196:199], v[112:127]
  s_add_u32 s20, s20, 4096
  s_addc_u32 s21, s21, 0
  s_add_u32 s22, s22, 4096
  s_addc_u32 s23, s23, 0
  s_add_u32 s24, s24, 4096
  s_addc_u32 s25, s25, 0
  s_add_u32 s26, s26, 4096
  s_addc_u32 s27, s27, 0
  global_load_dwordx4 v[192:195], v3, s[20:21] offset:0
  global_load_dwordx4 v[196:199], v3, s[22:23] offset:0
  global_load_dwordx4 v[200:203], v3, s[24:25] offset:0
  global_load_dwordx4 v[204:207], v3, s[26:27] offset:0
  s_waitcnt vmcnt(28)
  v_mfma_f32_32x32x16_bf16 v[64:79], v[216:219], v[208:211], v[64:79]
  v_mfma_f32_32x32x16_bf16 v[80:95], v[220:223], v[208:211], v[80:95]
  v_mfma_f32_32x32x16_bf16 v[96:111], v[216:219], v[212:215], v[96:111]
  v_mfma_f32_32x32x16_bf16 v[112:127], v[220:223], v[212:215], v[112:127]
  global_load_dwordx4 v[208:211], v3, s[20:21] offset:1024
  global_load_dwordx4 v[212:215], v3, s[22:23] offset:1024
  global_load_dwordx4 v[216:219], v3, s[24:25] offset:1024
  global_load_dwordx4 v[220:223], v3, s[26:27] offset:1024
  s_waitcnt vmcnt(28)
  v_mfma_f32_32x32x16_bf16 v[64:79], v[232:235], v[224:227], v[64:79]
  v_mfma_f32_32x32x16_bf16 v[80:95], v[236:239], v[224:227], v[80:95]
  v_mfma_f32_32x32x16_bf16 v[96:111], v[232:235], v[228:231], v[96:111]
  v_mfma_f32_32x32x16_bf16 v[112:127], v[236:239], v[228:231], v[112:127]
  global_load_dwordx4 v[224:227], v3, s[20:21] offset:2048
  global_load_dwordx4 v[228:231], v3, s[22:23] offset:2048
  global_load_dwordx4 v[232:235], v3, s[24:25] offset:2048
  global_load_dwordx4 v[236:239], v3, s[26:27] offset:2048
  s_waitcnt vmcnt(28)
  v_mfma_f32_32x32x16_bf16 v[64:79], v[248:251], v[240:243], v[64:79]
  v_mfma_f32_32x32x16_bf16 v[80:95], v[252:255], v[240:243], v[80:95]
  v_mfma_f32_32x32x16_bf16 v[96:111], v[248:251], v[244:247], v[96:111]
  v_mfma_f32_32x32x16_bf16 v[112:127], v[252:255], v[244:247], v[112:127]
  global_load_dwordx4 v[240:243], v3, s[20:21] offset:3072
  global_load_dwordx4 v[244:247], v3, s[22:23] offset:3072
  global_load_dwordx4 v[248:251], v3, s[24:25] offset:3072
  global_load_dwordx4 v[252:255], v3, s[26:27] offset:3072
  s_waitcnt vmcnt(28)
  v_mfma_f32_32x32x16_bf16 v[64:79], v[136:139], v[128:131], v[64:79]
  v_mfma_f32_32x32x16_bf16 v[80:95], v[140:143], v[128:131], v[80:95]
  v_mfma_f32_32x32x16_bf16 v[96:111], v[136:139], v[132:135], v[96:111]
  v_mfma_f32_32x32x16_bf16 v[112:127], v[140:143], v[132:135], v[112:127]
  s_add_u32 s20, s20, 4096
  s_addc_u32 s21, s21, 0
  s_add_u32 s22, s22, 4096
  s_addc_u32 s23, s23, 0
  s_add_u32 s24, s24, 4096
  s_addc_u32 s25, s25, 0
  s_add_u32 s26, s26, 4096
  s_addc_u32 s27, s27, 0
  global_load_dwordx4 v[128:131], v3, s[20:21] offset:0
  global_load_dwordx4 v[132:135], v3, s[22:23] offset:0
  global_load_dwordx4 v[136:139], v3, s[24:25] offset:0
  global_load_dwordx4 v[140:143], v3, s[26:27] offset:0
  s_waitcnt vmcnt(28)
  v_mfma_f32_32x32x16_bf16 v[64:79], v[152:155], v[144:147], v[64:79]
  v_mfma_f32_32x32x16_bf16 v[80:95], v[156:159], v[144:147], v[80:95]
  v_mfma_f32_32x32x16_bf16 v[96:111], v[152:155], v[148:151], v[96:111]
  v_mfma_f32_32x32x16_bf16 v[112:127], v[156:159], v[148:151], v[112:127]
  global_load_dwordx4 v[144:147], v3, s[20:21] offset:1024
  global_load_dwordx4 v[148:151], v3, s[22:23] offset:1024
  global_load_dwordx4 v[152:155], v3, s[24:25] offset:1024
  global_load_dwordx4 v[156:159], v3, s[26:27] offset:1024
  s_waitcnt vmcnt(28)
  v_mfma_f32_32x32x16_bf16 v[64:79], v[168:171], v[160:163], v[64:79]
  v_mfma_f32_32x32x16_bf16 v[80:95], v[172:175], v[160:163], v[80:95]
  v_mfma_f32_32x32x16_bf16 v[96:111], v[168:171], v[164:167], v[96:111]
  v_mfma_f32_32x32x16_bf16 v[112:127], v[172:175], v[164:167], v[112:127]
  global_load_dwordx4 v[160:163], v3, s[20:21] offset:2048
  global_load_dwordx4 v[164:167], v3, s[22:23] offset:2048
  global_load_dwordx4 v[168:171], v3, s[24:25] offset:2048
  global_load_dwordx4 v[172:175], v3, s[26:27] offset:2048
  s_waitcnt vmcnt(28)
  v_mfma_f32_32x32x16_bf16 v[64:79], v[184:187], v[176:179], v[64:79]
  v_mfma_f32_32x32x16_bf16 v[80:95], v[188:191], v[176:179], v[80:95]
  v_mfma_f32_32x32x16_bf16 v[96:111], v[184:187], v[180:183], v[96:111]
  v_mfma_f32_32x32x16_bf16 v[112:127], v[188:191], v[180:183], v[112:127]
  global_load_dwordx4 v[176:179], v3, s[20:21] offset:3072
  global_load_dwordx4 v[180:183], v3, s[22:23] offset:3072
  global_load_dwordx4 v[184:187], v3, s[24:25] offset:3072
  global_load_dwordx4 v[188:191], v3, s[26:27] offset:3072
  s_waitcnt vmcnt(28)
  v_mfma_f32_32x32x16_bf16 v[64:79], v[200:203], v[192:195], v[64:79]
  v_mfma_f32_32x32x16_bf16 v[80:95], v[204:207], v[192:195], v[80:95]
  v_mfma_f32_32x32x16_bf16 v[96:111], v[200:203], v[196:199], v[96:111]
  v_mfma_f32_32x32x16_bf16 v[112:127], v[204:207], v[196:199], v[112:127]
  s_waitcnt vmcnt(24)
  v_mfma_f32_32x32x16_bf16 v[64:79], v[216:219], v[208:211], v[64:79]
  v_mfma_f32_32x32x16_bf16 v[80:95], v[220:223], v[208:211], v[80:95]
  v_mfma_f32_32x32x16_bf16 v[96:111], v[216:219], v[212:215], v[96:111]
  v_mfma_f32_32x32x16_bf16 v[112:127], v[220:223], v[212:215], v[112:127]
  s_waitcnt vmcnt(20)
  v_mfma_f32_32x32x16_bf16 v[64:79], v[232:235], v[224:227], v[64:79]
  v_mfma_f32_32x32x16_bf16 v[80:95], v[236:239], v[224:227], v[80:95]
  v_mfma_f32_32x32x16_bf16 v[96:111], v[232:235], v[228:231], v[96:111]
  v_mfma_f32_32x32x16_bf16 v[112:127], v[236:239], v[228:231], v[112:127]
  s_waitcnt vmcnt(16)
  v_mfma_f32_32x32x16_bf16 v[64:79], v[248:251], v[240:243], v[64:79]
  v_mfma_f32_32x32x16_bf16 v[80:95], v[252:255], v[240:243], v[80:95]
  v_mfma_f32_32x32x16_bf16 v[96:111], v[248:251], v[244:247], v[96:111]
  v_mfma_f32_32x32x16_bf16 v[112:127], v[252:255], v[244:247], v[112:127]
  s_waitcnt vmcnt(12)
  v_mfma_f32_32x32x16_bf16 v[64:79], v[136:139], v[128:131], v[64:79]
  v_mfma_f32_32x32x16_bf16 v[80:95], v[140:143], v[128:131], v[80:95]
  v_mfma_f32_32x32x16_bf16 v[96:111], v[136:139], v[132:135], v[96:111]
  v_mfma_f32_32x32x16_bf16 v[112:127], v[140:143], v[132:135], v[112:127]
  s_waitcnt vmcnt(8)
  v_mfma_f32_32x32x16_bf16 v[64:79], v[152:155], v[144:147], v[64:79]
  v_mfma_f32_32x32x16_bf16 v[80:95], v[156:159], v[144:147], v[80:95]
  v_mfma_f32_32x32x16_bf16 v[96:111], v[152:155], v[148:151], v[96:111]
  v_mfma_f32_32x32x16_bf16 v[112:127], v[156:159], v[148:151], v[112:127]
  s_waitcnt vmcnt(4)
  v_mfma_f32_32x32x16_bf16 v[64:79], v[168:171], v[160:163], v[64:79]
  v_mfma_f32_32x32x16_bf16 v[80:95], v[172:175], v[160:163], v[80:95]
  v_mfma_f32_32x32x16_bf16 v[96:111], v[168:171], v[164:167], v[96:111]
  v_mfma_f32_32x32x16_bf16 v[112:127], v[172:175], v[164:167], v[112:127]
  s_waitcnt vmcnt(0)
  v_mfma_f32_32x32x16_bf16 v[64:79], v[184:187], v[176:179], v[64:79]
  v_mfma_f32_32x32x16_bf16 v[80:95], v[188:191], v[176:179], v[80:95]
  v_mfma_f32_32x32x16_bf16 v[96:111], v[184:187], v[180:183], v[96:111]
  v_mfma_f32_32x32x16_bf16 v[112:127], v[188:191], v[180:183], v[112:127]
  s_nop 15
  s_nop 15
  s_cmp_eq_u32 s28, 0
  s_cbranch_scc0 K1_kfix
  v_mul_f32 v64, 0x3e8b97f6, v64
  v_mul_f32 v65, 0x3e8b97f6, v65
  v_mul_f32 v66, 0x3e8b97f6, v66
  v_mul_f32 v67, 0x3e8b97f6, v67
  v_mul_f32 v68, 0x3e8b97f6, v68
  v_mul_f32 v69, 0x3e8b97f6, v69
  v_mul_f32 v70, 0x3e8b97f6, v70
  v_mul_f32 v71, 0x3e8b97f6, v71
  v_mul_f32 v72, 0x3e8b97f6, v72
  v_mul_f32 v73, 0x3e8b97f6, v73
  v_mul_f32 v74, 0x3e8b97f6, v74
  v_mul_f32 v75, 0x3e8b97f6, v75
  v_mul_f32 v76, 0x3e8b97f6, v76
  v_mul_f32 v77, 0x3e8b97f6, v77
  v_mul_f32 v78, 0x3e8b97f6, v78
  v_mul_f32 v79, 0x3e8b97f6, v79
  v_mul_f32 v80, 0x3e8b97f6, v80
  v_mul_f32 v81, 0x3e8b97f6, v81
  v_mul_f32 v82, 0x3e8b97f6, v82
  v_mul_f32 v83, 0x3e8b97f6, v83
  v_mul_f32 v84, 0x3e8b97f6, v84
  v_mul_f32 v85, 0x3e8b97f6, v85
  v_mul_f32 v86, 0x3e8b97f6, v86
  v_mul_f32 v87, 0x3e8b97f6, v87
  v_mul_f32 v88, 0x3e8b97f6, v88
  v_mul_f32 v89, 0x3e8b97f6, v89
  v_mul_f32 v90, 0x3e8b97f6, v90
  v_mul_f32 v91, 0x3e8b97f6, v91
  v_mul_f32 v92, 0x3e8b97f6, v92
  v_mul_f32 v93, 0x3e8b97f6, v93
  v_mul_f32 v94, 0x3e8b97f6, v94
  v_mul_f32 v95, 0x3e8b97f6, v95
  v_mul_f32 v96, 0x3e8b97f6, v96
  v_mul_f32 v97, 0x3e8b97f6, v97
  v_mul_f32 v98, 0x3e8b97f6, v98
  v_mul_f32 v99, 0x3e8b97f6, v99
  v_mul_f32 v100, 0x3e8b97f6, v100
  v_mul_f32 v101, 0x3e8b97f6, v101
  v_mul_f32 v102, 0x3e8b97f6, v102
  v_mul_f32 v103, 0x3e8b97f6, v103
  v_mul_f32 v104, 0x3e8b97f6, v104
  v_mul_f32 v105, 0x3e8b97f6, v105
  v_mul_f32 v106, 0x3e8b97f6, v106
  v_mul_f32 v107, 0x3e8b97f6, v107
  v_mul_f32 v108, 0x3e8b97f6, v108
  v_mul_f32 v109, 0x3e8b97f6, v109
  v_mul_f32 v110, 0x3e8b97f6, v110
  v_mul_f32 v111, 0x3e8b97f6, v111
  v_mul_f32 v112, 0x3e8b97f6, v112
  v_mul_f32 v113, 0x3e8b97f6, v113
  v_mul_f32 v114, 0x3e8b97f6, v114
  v_mul_f32 v115, 0x3e8b97f6, v115
  v_mul_f32 v116, 0x3e8b97f6, v116
  v_mul_f32 v117, 0x3e8b97f6, v117
  v_mul_f32 v118, 0x3e8b97f6, v118
  v_mul_f32 v119, 0x3e8b97f6, v119
  v_mul_f32 v120, 0x3e8b97f6, v120
  v_mul_f32 v121, 0x3e8b97f6, v121
  v_mul_f32 v122, 0x3e8b97f6, v122
  v_mul_f32 v123, 0x3e8b97f6, v123
  v_mul_f32 v124, 0x3e8b97f6, v124
  v_mul_f32 v125, 0x3e8b97f6, v125
  v_mul_f32 v126, 0x3e8b97f6, v126
  v_mul_f32 v127, 0x3e8b97f6, v127
  s_add_u32 s31, s31, 5570560
  s_branch K1_qkstore
K1_kfix:
  s_mov_b32 exec_lo, 0
  v_mov_b32 v76, 1.0
  v_mov_b32 v77, 1.0
  v_mov_b32 v78, 1.0
  v_mov_b32 v92, 1.0
  v_mov_b32 v93, 1.0
  v_mov_b32 v94, 1.0
  v_mov_b32 v108, 1.0
  v_mov_b32 v109, 1.0
  v_mov_b32 v110, 1.0
  v_mov_b32 v124, 1.0
  v_mov_b32 v125, 1.0
  v_mov_b32 v126, 1.0
  s_mov_b64 exec, -1
  s_add_u32 s31, s31, 7667712
K1_qkstore:
  v_cvt_pk_bf16_f32 v128, v64, v65
  v_cvt_pk_bf16_f32 v129, v66, v67
  v_cvt_pk_bf16_f32 v130, v68, v69
  v_cvt_pk_bf16_f32 v131, v70, v71
  v_cvt_pk_bf16_f32 v132, v72, v73
  v_cvt_pk_bf16_f32 v133, v74, v75
  v_cvt_pk_bf16_f32 v134, v76, v77
  v_cvt_pk_bf16_f32 v135, v78, v79
  s_add_u32 s18, s31, 0
  s_add_u32 s32, s12, s18
  s_addc_u32 s33, s13, 0
  global_store_dwordx4 v3, v[128:131], s[32:33]
  global_store_dwordx4 v3, v[132:135], s[32:33] offset:1024
  s_nop 1
  v_cvt_pk_bf16_f32 v128, v80, v81
  v_cvt_pk_bf16_f32 v129, v82, v83
  v_cvt_pk_bf16_f32 v130, v84, v85
  v_cvt_pk_bf16_f32 v131, v86, v87
  v_cvt_pk_bf16_f32 v132, v88, v89
  v_cvt_pk_bf16_f32 v133, v90, v91
  v_cvt_pk_bf16_f32 v134, v92, v93
  v_cvt_pk_bf16_f32 v135, v94, v95
  s_add_u32 s18, s31, 131072
  s_add_u32 s32, s12, s18
  s_addc_u32 s33, s13, 0
  global_store_dwordx4 v3, v[128:131], s[32:33]
  global_store_dwordx4 v3, v[132:135], s[32:33] offset:1024
  s_nop 1
  v_cvt_pk_bf16_f32 v128, v96, v97
  v_cvt_pk_bf16_f32 v129, v98, v99
  v_cvt_pk_bf16_f32 v130, v100, v101
  v_cvt_pk_bf16_f32 v131, v102, v103
  v_cvt_pk_bf16_f32 v132, v104, v105
  v_cvt_pk_bf16_f32 v133, v106, v107
  v_cvt_pk_bf16_f32 v134, v108, v109
  v_cvt_pk_bf16_f32 v135, v110, v111
  s_add_u32 s18, s31, 2048
  s_add_u32 s32, s12, s18
  s_addc_u32 s33, s13, 0
  global_store_dwordx4 v3, v[128:131], s[32:33]
  global_store_dwordx4 v3, v[132:135], s[32:33] offset:1024
  s_nop 1
  v_cvt_pk_bf16_f32 v128, v112, v113
  v_cvt_pk_bf16_f32 v129, v114, v115
  v_cvt_pk_bf16_f32 v130, v116, v117
  v_cvt_pk_bf16_f32 v131, v118, v119
  v_cvt_pk_bf16_f32 v132, v120, v121
  v_cvt_pk_bf16_f32 v133, v122, v123
  v_cvt_pk_bf16_f32 v134, v124, v125
  v_cvt_pk_bf16_f32 v135, v126, v127
  s_add_u32 s18, s31, 133120
  s_add_u32 s32, s12, s18
  s_addc_u32 s33, s13, 0
  global_store_dwordx4 v3, v[128:131], s[32:33]
  global_store_dwordx4 v3, v[132:135], s[32:33] offset:1024
  s_nop 1
  s_branch K1_end
K1_vpath:
  global_load_dwordx4 v[128:131], v3, s[20:21] offset:0
  global_load_dwordx4 v[132:135], v3, s[22:23] offset:0
  global_load_dwordx4 v[136:139], v3, s[24:25] offset:0
  global_load_dwordx4 v[140:143], v3, s[26:27] offset:0
  global_load_dwordx4 v[144:147], v3, s[20:21] offset:1024
  global_load_dwordx4 v[148:151], v3, s[22:23] offset:1024
  global_load_dwordx4 v[152:155], v3, s[24:25] offset:1024
  global_load_dwordx4 v[156:159], v3, s[26:27] offset:1024
  global_load_dwordx4 v[160:163], v3, s[20:21] offset:2048
  global_load_dwordx4 v[164:167], v3, s[22:23] offset:2048
  global_load_dwordx4 v[168:171], v3, s[24:25] offset:2048
  global_load_dwordx4 v[172:175], v3, s[26:27] offset:2048
  global_load_dwordx4 v[176:179], v3, s[20:21] offset:3072
  global_load_dwordx4 v[180:183], v3, s[22:23] offset:3072
  global_load_dwordx4 v[184:187], v3, s[24:25] offset:3072
  global_load_dwordx4 v[188:191], v3, s[26:27] offset:3072
  s_add_u32 s20, s20, 4096
  s_addc_u32 s21, s21, 0
  s_add_u32 s22, s22, 4096
  s_addc_u32 s23, s23, 0
  s_add_u32 s24, s24, 4096
  s_addc_u32 s25, s25, 0
  s_add_u32 s26, s26, 4096
  s_addc_u32 s27, s27, 0
  global_load_dwordx4 v[192:195], v3, s[20:21] offset:0
  global_load_dwordx4 v[196:199], v3, s[22:23] offset:0
  global_load_dwordx4 v[200:203], v3, s[24:25] offset:0
  global_load_dwordx4 v[204:207], v3, s[26:27] offset:0
  global_load_dwordx4 v[208:211], v3, s[20:21] offset:1024
  global_load_dwordx4 v[212:215], v3, s[22:23] offset:1024
  global_load_dwordx4 v[216:219], v3, s[24:25] offset:1024
  global_load_dwordx4 v[220:223], v3, s[26:27] offset:1024
  global_load_dwordx4 v[224:227], v3, s[20:21] offset:2048
  global_load_dwordx4 v[228:231], v3, s[22:23] offset:2048
  global_load_dwordx4 v[232:235], v3, s[24:25] offset:2048
  global_load_dwordx4 v[236:239], v3, s[26:27] offset:2048
  global_load_dwordx4 v[240:243], v3, s[20:21] offset:3072
  global_load_dwordx4 v[244:247], v3, s[22:23] offset:3072
  global_load_dwordx4 v[248:251], v3, s[24:25] offset:3072
  global_load_dwordx4 v[252:255], v3, s[26:27] offset:3072
  s_waitcnt vmcnt(28)
  v_mfma_f32_32x32x16_bf16 v[64:79], v[128:131], v[136:139], 0
  v_mfma_f32_32x32x16_bf16 v[80:95], v[128:131], v[140:143], 0
  v_mfma_f32_32x32x16_bf16 v[96:111], v[132:135], v[136:139], 0
  v_mfma_f32_32x32x16_bf16 v[112:127], v[132:135], v[140:143], 0
  s_add_u32 s20, s20, 4096
  s_addc_u32 s21, s21, 0
  s_add_u32 s22, s22, 4096
  s_addc_u32 s23, s23, 0
  s_add_u32 s24, s24, 4096
  s_addc_u32 s25, s25, 0
  s_add_u32 s26, s26, 4096
  s_addc_u32 s27, s27, 0
  global_load_dwordx4 v[128:131], v3, s[20:21] offset:0
  global_load_dwordx4 v[132:135], v3, s[22:23] offset:0
  global_load_dwordx4 v[136:139], v3, s[24:25] offset:0
  global_load_dwordx4 v[140:143], v3, s[26:27] offset:0
  s_waitcnt vmcnt(28)
  v_mfma_f32_32x32x16_bf16 v[64:79], v[144:147], v[152:155], v[64:79]
  v_mfma_f32_32x32x16_bf16 v[80:95], v[144:147], v[156:159], v[80:95]
  v_mfma_f32_32x32x16_bf16 v[96:111], v[148:151], v[152:155], v[96:111]
  v_mfma_f32_32x32x16_bf16 v[112:127], v[148:151], v[156:159], v[112:127]
  global_load_dwordx4 v[144:147], v3, s[20:21] offset:1024
  global_load_dwordx4 v[148:151], v3, s[22:23] offset:1024
  global_load_dwordx4 v[152:155], v3, s[24:25] offset:1024
  global_load_dwordx4 v[156:159], v3, s[26:27] offset:1024
  s_waitcnt vmcnt(28)
  v_mfma_f32_32x32x16_bf16 v[64:79], v[160:163], v[168:171], v[64:79]
  v_mfma_f32_32x32x16_bf16 v[80:95], v[160:163], v[172:175], v[80:95]
  v_mfma_f32_32x32x16_bf16 v[96:111], v[164:167], v[168:171], v[96:111]
  v_mfma_f32_32x32x16_bf16 v[112:127], v[164:167], v[172:175], v[112:127]
  global_load_dwordx4 v[160:163], v3, s[20:21] offset:2048
  global_load_dwordx4 v[164:167], v3, s[22:23] offset:2048
  global_load_dwordx4 v[168:171], v3, s[24:25] offset:2048
  global_load_dwordx4 v[172:175], v3, s[26:27] offset:2048
  s_waitcnt vmcnt(28)
  v_mfma_f32_32x32x16_bf16 v[64:79], v[176:179], v[184:187], v[64:79]
  v_mfma_f32_32x32x16_bf16 v[80:95], v[176:179], v[188:191], v[80:95]
  v_mfma_f32_32x32x16_bf16 v[96:111], v[180:183], v[184:187], v[96:111]
  v_mfma_f32_32x32x16_bf16 v[112:127], v[180:183], v[188:191], v[112:127]
  global_load_dwordx4 v[176:179], v3, s[20:21] offset:3072
  global_load_dwordx4 v[180:183], v3, s[22:23] offset:3072
  global_load_dwordx4 v[184:187], v3, s[24:25] offset:3072
  global_load_dwordx4 v[188:191], v3, s[26:27] offset:3072
  s_waitcnt vmcnt(28)
  v_mfma_f32_32x32x16_bf16 v[64:79], v[192:195], v[200:203], v[64:79]
  v_mfma_f32_32x32x16_bf16 v[80:95], v[192:195], v[204:207], v[80:95]
  v_mfma_f32_32x32x16_bf16 v[96:111], v[196:199], v[200:203], v[96:111]
  v_mfma_f32_32x32x16_bf16 v[112:127], v[196:199], v[204:207], v[112:127]
  s_add_u32 s20, s20, 4096
  s_addc_u32 s21, s21, 0
  s_add_u32 s22, s22, 4096
  s_addc_u32 s23, s23, 0
  s_add_u32 s24, s24, 4096
  s_addc_u32 s25, s25, 0
  s_add_u32 s26, s26, 4096
  s_addc_u32 s27, s27, 0
  global_load_dwordx4 v[192:195], v3, s[20:21] offset:0
  global_load_dwordx4 v[196:199], v3, s[22:23] offset:0
  global_load_dwordx4 v[200:203], v3, s[24:25] offset:0
  global_load_dwordx4 v[204:207], v3, s[26:27] offset:0
  s_waitcnt vmcnt(28)
  v_mfma_f32_32x32x16_bf16 v[64:79], v[208:211], v[216:219], v[64:79]
  v_mfma_f32_32x32x16_bf16 v[80:95], v[208:211], v[220:223], v[80:95]
  v_mfma_f32_32x32x16_bf16 v[96:111], v[212:215], v[216:219], v[96:111]
  v_mfma_f32_32x32x16_bf16 v[112:127], v[212:215], v[220:223], v[112:127]
  global_load_dwordx4 v[208:211], v3, s[20:21] offset:1024
  global_load_dwordx4 v[212:215], v3, s[22:23] offset:1024
  global_load_dwordx4 v[216:219], v3, s[24:25] offset:1024
  global_load_dwordx4 v[220:223], v3, s[26:27] offset:1024
  s_waitcnt vmcnt(28)
  v_mfma_f32_32x32x16_bf16 v[64:79], v[224:227], v[232:235], v[64:79]
  v_mfma_f32_32x32x16_bf16 v[80:95], v[224:227], v[236:239], v[80:95]
  v_mfma_f32_32x32x16_bf16 v[96:111], v[228:231], v[232:235], v[96:111]
  v_mfma_f32_32x32x16_bf16 v[112:127], v[228:231], v[236:239], v[112:127]
  global_load_dwordx4 v[224:227], v3, s[20:21] offset:2048
  global_load_dwordx4 v[228:231], v3, s[22:23] offset:2048
  global_load_dwordx4 v[232:235], v3, s[24:25] offset:2048
  global_load_dwordx4 v[236:239], v3, s[26:27] offset:2048
  s_waitcnt vmcnt(28)
  v_mfma_f32_32x32x16_bf16 v[64:79], v[240:243], v[248:251], v[64:79]
  v_mfma_f32_32x32x16_bf16 v[80:95], v[240:243], v[252:255], v[80:95]
  v_mfma_f32_32x32x16_bf16 v[96:111], v[244:247], v[248:251], v[96:111]
  v_mfma_f32_32x32x16_bf16 v[112:127], v[244:247], v[252:255], v[112:127]
  global_load_dwordx4 v[240:243], v3, s[20:21] offset:3072
  global_load_dwordx4 v[244:247], v3, s[22:23] offset:3072
  global_load_dwordx4 v[248:251], v3, s[24:25] offset:3072
  global_load_dwordx4 v[252:255], v3, s[26:27] offset:3072
  s_waitcnt vmcnt(28)
  v_mfma_f32_32x32x16_bf16 v[64:79], v[128:131], v[136:139], v[64:79]
  v_mfma_f32_32x32x16_bf16 v[80:95], v[128:131], v[140:143], v[80:95]
  v_mfma_f32_32x32x16_bf16 v[96:111], v[132:135], v[136:139], v[96:111]
  v_mfma_f32_32x32x16_bf16 v[112:127], v[132:135], v[140:143], v[112:127]
  s_add_u32 s20, s20, 4096
  s_addc_u32 s21, s21, 0
  s_add_u32 s22, s22, 4096
  s_addc_u32 s23, s23, 0
  s_add_u32 s24, s24, 4096
  s_addc_u32 s25, s25, 0
  s_add_u32 s26, s26, 4096
  s_addc_u32 s27, s27, 0
  global_load_dwordx4 v[128:131], v3, s[20:21] offset:0
  global_load_dwordx4 v[132:135], v3, s[22:23] offset:0
  global_load_dwordx4 v[136:139], v3, s[24:25] offset:0
  global_load_dwordx4 v[140:143], v3, s[26:27] offset:0
  s_waitcnt vmcnt(28)
  v_mfma_f32_32x32x16_bf16 v[64:79], v[144:147], v[152:155], v[64:79]
  v_mfma_f32_32x32x16_bf16 v[80:95], v[144:147], v[156:159], v[80:95]
  v_mfma_f32_32x32x16_bf16 v[96:111], v[148:151], v[152:155], v[96:111]
  v_mfma_f32_32x32x16_bf16 v[112:127], v[148:151], v[156:159], v[112:127]
  global_load_dwordx4 v[144:147], v3, s[20:21] offset:1024
  global_load_dwordx4 v[148:151], v3, s[22:23] offset:1024
  global_load_dwordx4 v[152:155], v3, s[24:25] offset:1024
  global_load_dwordx4 v[156:159], v3, s[26:27] offset:1024
  s_waitcnt vmcnt(28)
  v_mfma_f32_32x32x16_bf16 v[64:79], v[160:163], v[168:171], v[64:79]
  v_mfma_f32_32x32x16_bf16 v[80:95], v[160:163], v[172:175], v[80:95]
  v_mfma_f32_32x32x16_bf16 v[96:111], v[164:167], v[168:171], v[96:111]
  v_mfma_f32_32x32x16_bf16 v[112:127], v[164:167], v[172:175], v[112:127]
  global_load_dwordx4 v[160:163], v3, s[20:21] offset:2048
  global_load_dwordx4 v[164:167], v3, s[22:23] offset:2048
  global_load_dwordx4 v[168:171], v3, s[24:25] offset:2048
  global_load_dwordx4 v[172:175], v3, s[26:27] offset:2048
  s_waitcnt vmcnt(28)
  v_mfma_f32_32x32x16_bf16 v[64:79], v[176:179], v[184:187], v[64:79]
  v_mfma_f32_32x32x16_bf16 v[80:95], v[176:179], v[188:191], v[80:95]
  v_mfma_f32_32x32x16_bf16 v[96:111], v[180:183], v[184:187], v[96:111]
  v_mfma_f32_32x32x16_bf16 v[112:127], v[180:183], v[188:191], v[112:127]
  global_load_dwordx4 v[176:179], v3, s[20:21] offset:3072
  global_load_dwordx4 v[180:183], v3, s[22:23] offset:3072
  global_load_dwordx4 v[184:187], v3, s[24:25] offset:3072
  global_load_dwordx4 v[188:191], v3, s[26:27] offset:3072
  s_waitcnt vmcnt(28)
  v_mfma_f32_32x32x16_bf16 v[64:79], v[192:195], v[200:203], v[64:79]
  v_mfma_f32_32x32x16_bf16 v[80:95], v[192:195], v[204:207], v[80:95]
  v_mfma_f32_32x32x16_bf16 v[96:111], v[196:199], v[200:203], v[96:111]
  v_mfma_f32_32x32x16_bf16 v[112:127], v[196:199], v[204:207], v[112:127]
  s_add_u32 s20, s20, 4096
  s_addc_u32 s21, s21, 0
  s_add_u32 s22, s22, 4096
  s_addc_u32 s23, s23, 0
  s_add_u32 s24, s24, 4096
  s_addc_u32 s25, s25, 0
  s_add_u32 s26, s26, 4096
  s_addc_u32 s27, s27, 0
  global_load_dwordx4 v[192:195], v3, s[20:21] offset:0
  global_load_dwordx4 v[196:199], v3, s[22:23] offset:0
  global_load_dwordx4 v[200:203], v3, s[24:25] offset:0
  global_load_dwordx4 v[204:207], v3, s[26:27] offset:0
  s_waitcnt vmcnt(28)
  v_mfma_f32_32x32x16_bf16 v[64:79], v[208:211], v[216:219], v[64:79]
  v_mfma_f32_32x32x16_bf16 v[80:95], v[208:211], v[220:223], v[80:95]
  v_mfma_f32_32x32x16_bf16 v[96:111], v[212:215], v[216:219], v[96:111]
  v_mfma_f32_32x32x16_bf16 v[112:127], v[212:215], v[220:223], v[112:127]
  global_load_dwordx4 v[208:211], v3, s[20:21] offset:1024
  global_load_dwordx4 v[212:215], v3, s[22:23] offset:1024
  global_load_dwordx4 v[216:219], v3, s[24:25] offset:1024
  global_load_dwordx4 v[220:223], v3, s[26:27] offset:1024
  s_waitcnt vmcnt(28)
  v_mfma_f32_32x32x16_bf16 v[64:79], v[224:227], v[232:235], v[64:79]
  v_mfma_f32_32x32x16_bf16 v[80:95], v[224:227], v[236:239], v[80:95]
  v_mfma_f32_32x32x16_bf16 v[96:111], v[228:231], v[232:235], v[96:111]
  v_mfma_f32_32x32x16_bf16 v[112:127], v[228:231], v[236:239], v[112:127]
  global_load_dwordx4 v[224:227], v3, s[20:21] offset:2048
  global_load_dwordx4 v[228:231], v3, s[22:23] offset:2048
  global_load_dwordx4 v[232:235], v3, s[24:25] offset:2048
  global_load_dwordx4 v[236:239], v3, s[26:27] offset:2048
  s_waitcnt vmcnt(28)
  v_mfma_f32_32x32x16_bf16 v[64:79], v[240:243], v[248:251], v[64:79]
  v_mfma_f32_32x32x16_bf16 v[80:95], v[240:243], v[252:255], v[80:95]
  v_mfma_f32_32x32x16_bf16 v[96:111], v[244:247], v[248:251], v[96:111]
  v_mfma_f32_32x32x16_bf16 v[112:127], v[244:247], v[252:255], v[112:127]
  global_load_dwordx4 v[240:243], v3, s[20:21] offset:3072
  global_load_dwordx4 v[244:247], v3, s[22:23] offset:3072
  global_load_dwordx4 v[248:251], v3, s[24:25] offset:3072
  global_load_dwordx4 v[252:255], v3, s[26:27] offset:3072
  s_waitcnt vmcnt(28)
  v_mfma_f32_32x32x16_bf16 v[64:79], v[128:131], v[136:139], v[64:79]
  v_mfma_f32_32x32x16_bf16 v[80:95], v[128:131], v[140:143], v[80:95]
  v_mfma_f32_32x32x16_bf16 v[96:111], v[132:135], v[136:139], v[96:111]
  v_mfma_f32_32x32x16_bf16 v[112:127], v[132:135], v[140:143], v[112:127]
  s_add_u32 s20, s20, 4096
  s_addc_u32 s21, s21, 0
  s_add_u32 s22, s22, 4096
  s_addc_u32 s23, s23, 0
  s_add_u32 s24, s24, 4096
  s_addc_u32 s25, s25, 0
  s_add_u32 s26, s26, 4096
  s_addc_u32 s27, s27, 0
  global_load_dwordx4 v[128:131], v3, s[20:21] offset:0
  global_load_dwordx4 v[132:135], v3, s[22:23] offset:0
  global_load_dwordx4 v[136:139], v3, s[24:25] offset:0
  global_load_dwordx4 v[140:143], v3, s[26:27] offset:0
  s_waitcnt vmcnt(28)
  v_mfma_f32_32x32x16_bf16 v[64:79], v[144:147], v[152:155], v[64:79]
  v_mfma_f32_32x32x16_bf16 v[80:95], v[144:147], v[156:159], v[80:95]
  v_mfma_f32_32x32x16_bf16 v[96:111], v[148:151], v[152:155], v[96:111]
  v_mfma_f32_32x32x16_bf16 v[112:127], v[148:151], v[156:159], v[112:127]
  global_load_dwordx4 v[144:147], v3, s[20:21] offset:1024
  global_load_dwordx4 v[148:151], v3, s[22:23] offset:1024
  global_load_dwordx4 v[152:155], v3, s[24:25] offset:1024
  global_load_dwordx4 v[156:159], v3, s[26:27] offset:1024
  s_waitcnt vmcnt(28)
  v_mfma_f32_32x32x16_bf16 v[64:79], v[160:163], v[168:171], v[64:79]
  v_mfma_f32_32x32x16_bf16 v[80:95], v[160:163], v[172:175], v[80:95]
  v_mfma_f32_32x32x16_bf16 v[96:111], v[164:167], v[168:171], v[96:111]
  v_mfma_f32_32x32x16_bf16 v[112:127], v[164:167], v[172:175], v[112:127]
  global_load_dwordx4 v[160:163], v3, s[20:21] offset:2048
  global_load_dwordx4 v[164:167], v3, s[22:23] offset:2048
  global_load_dwordx4 v[168:171], v3, s[24:25] offset:2048
  global_load_dwordx4 v[172:175], v3, s[26:27] offset:2048
  s_waitcnt vmcnt(28)
  v_mfma_f32_32x32x16_bf16 v[64:79], v[176:179], v[184:187], v[64:79]
  v_mfma_f32_32x32x16_bf16 v[80:95], v[176:179], v[188:191], v[80:95]
  v_mfma_f32_32x32x16_bf16 v[96:111], v[180:183], v[184:187], v[96:111]
  v_mfma_f32_32x32x16_bf16 v[112:127], v[180:183], v[188:191], v[112:127]
  global_load_dwordx4 v[176:179], v3, s[20:21] offset:3072
  global_load_dwordx4 v[180:183], v3, s[22:23] offset:3072
  global_load_dwordx4 v[184:187], v3, s[24:25] offset:3072
  global_load_dwordx4 v[188:191], v3, s[26:27] offset:3072
  s_waitcnt vmcnt(28)
  v_mfma_f32_32x32x16_bf16 v[64:79], v[192:195], v[200:203], v[64:79]
  v_mfma_f32_32x32x16_bf16 v[80:95], v[192:195], v[204:207], v[80:95]
  v_mfma_f32_32x32x16_bf16 v[96:111], v[196:199], v[200:203], v[96:111]
  v_mfma_f32_32x32x16_bf16 v[112:127], v[196:199], v[204:207], v[112:127]
  s_waitcnt vmcnt(24)
  v_mfma_f32_32x32x16_bf16 v[64:79], v[208:211], v[216:219], v[64:79]
  v_mfma_f32_32x32x16_bf16 v[80:95], v[208:211], v[220:223], v[80:95]
  v_mfma_f32_32x32x16_bf16 v[96:111], v[212:215], v[216:219], v[96:111]
  v_mfma_f32_32x32x16_bf16 v[112:127], v[212:215], v[220:223], v[112:127]
  s_waitcnt vmcnt(20)
  v_mfma_f32_32x32x16_bf16 v[64:79], v[224:227], v[232:235], v[64:79]
  v_mfma_f32_32x32x16_bf16 v[80:95], v[224:227], v[236:239], v[80:95]
  v_mfma_f32_32x32x16_bf16 v[96:111], v[228:231], v[232:235], v[96:111]
  v_mfma_f32_32x32x16_bf16 v[112:127], v[228:231], v[236:239], v[112:127]
  s_waitcnt vmcnt(16)
  v_mfma_f32_32x32x16_bf16 v[64:79], v[240:243], v[248:251], v[64:79]
  v_mfma_f32_32x32x16_bf16 v[80:95], v[240:243], v[252:255], v[80:95]
  v_mfma_f32_32x32x16_bf16 v[96:111], v[244:247], v[248:251], v[96:111]
  v_mfma_f32_32x32x16_bf16 v[112:127], v[244:247], v[252:255], v[112:127]
  s_waitcnt vmcnt(12)
  v_mfma_f32_32x32x16_bf16 v[64:79], v[128:131], v[136:139], v[64:79]
  v_mfma_f32_32x32x16_bf16 v[80:95], v[128:131], v[140:143], v[80:95]
  v_mfma_f32_32x32x16_bf16 v[96:111], v[132:135], v[136:139], v[96:111]
  v_mfma_f32_32x32x16_bf16 v[112:127], v[132:135], v[140:143], v[112:127]
  s_waitcnt vmcnt(8)
  v_mfma_f32_32x32x16_bf16 v[64:79], v[144:147], v[152:155], v[64:79]
  v_mfma_f32_32x32x16_bf16 v[80:95], v[144:147], v[156:159], v[80:95]
  v_mfma_f32_32x32x16_bf16 v[96:111], v[148:151], v[152:155], v[96:111]
  v_mfma_f32_32x32x16_bf16 v[112:127], v[148:151], v[156:159], v[112:127]
  s_waitcnt vmcnt(4)
  v_mfma_f32_32x32x16_bf16 v[64:79], v[160:163], v[168:171], v[64:79]
  v_mfma_f32_32x32x16_bf16 v[80:95], v[160:163], v[172:175], v[80:95]
  v_mfma_f32_32x32x16_bf16 v[96:111], v[164:167], v[168:171], v[96:111]
  v_mfma_f32_32x32x16_bf16 v[112:127], v[164:167], v[172:175], v[112:127]
  s_waitcnt vmcnt(0)
  v_mfma_f32_32x32x16_bf16 v[64:79], v[176:179], v[184:187], v[64:79]
  v_mfma_f32_32x32x16_bf16 v[80:95], v[176:179], v[188:191], v[80:95]
  v_mfma_f32_32x32x16_bf16 v[96:111], v[180:183], v[184:187], v[96:111]
  v_mfma_f32_32x32x16_bf16 v[112:127], v[180:183], v[188:191], v[112:127]
  s_nop 15
  s_nop 15
  v_and_b32 v4, 31, v2
  v_cmp_eq_u32 vcc, 28, v4
  v_mov_b32 v5, 0
  v_mov_b32 v6, 0x3f803f80
  s_nop 1
  v_cndmask_b32 v5, v5, v6, vcc
  s_add_u32 s31, s31, 9764864
  v_cvt_pk_bf16_f32 v128, v64, v65
  v_cvt_pk_bf16_f32 v129, v66, v67
  v_cvt_pk_bf16_f32 v130, v68, v69
  v_cvt_pk_bf16_f32 v131, v70, v71
  v_cvt_pk_bf16_f32 v132, v72, v73
  v_cvt_pk_bf16_f32 v133, v74, v75
  v_cvt_pk_bf16_f32 v134, v76, v77
  v_cvt_pk_bf16_f32 v135, v78, v79
  v_or_b32 v128, v128, v5
  v_or_b32 v129, v129, v5
  v_or_b32 v130, v130, v5
  v_or_b32 v131, v131, v5
  v_or_b32 v132, v132, v5
  v_or_b32 v133, v133, v5
  v_or_b32 v134, v134, v5
  v_or_b32 v135, v135, v5
  s_add_u32 s18, s31, 0
  s_add_u32 s32, s12, s18
  s_addc_u32 s33, s13, 0
  global_store_dwordx4 v3, v[128:131], s[32:33]
  global_store_dwordx4 v3, v[132:135], s[32:33] offset:1024
  s_nop 1
  v_cvt_pk_bf16_f32 v128, v80, v81
  v_cvt_pk_bf16_f32 v129, v82, v83
  v_cvt_pk_bf16_f32 v130, v84, v85
  v_cvt_pk_bf16_f32 v131, v86, v87
  v_cvt_pk_bf16_f32 v132, v88, v89
  v_cvt_pk_bf16_f32 v133, v90, v91
  v_cvt_pk_bf16_f32 v134, v92, v93
  v_cvt_pk_bf16_f32 v135, v94, v95
  v_or_b32 v128, v128, v5
  v_or_b32 v129, v129, v5
  v_or_b32 v130, v130, v5
  v_or_b32 v131, v131, v5
  v_or_b32 v132, v132, v5
  v_or_b32 v133, v133, v5
  v_or_b32 v134, v134, v5
  v_or_b32 v135, v135, v5
  s_add_u32 s18, s31, 131072
  s_add_u32 s32, s12, s18
  s_addc_u32 s33, s13, 0
  global_store_dwordx4 v3, v[128:131], s[32:33]
  global_store_dwordx4 v3, v[132:135], s[32:33] offset:1024
  s_nop 1
  v_cvt_pk_bf16_f32 v128, v96, v97
  v_cvt_pk_bf16_f32 v129, v98, v99
  v_cvt_pk_bf16_f32 v130, v100, v101
  v_cvt_pk_bf16_f32 v131, v102, v103
  v_cvt_pk_bf16_f32 v132, v104, v105
  v_cvt_pk_bf16_f32 v133, v106, v107
  v_cvt_pk_bf16_f32 v134, v108, v109
  v_cvt_pk_bf16_f32 v135, v110, v111
  v_or_b32 v128, v128, v5
  v_or_b32 v129, v129, v5
  v_or_b32 v130, v130, v5
  v_or_b32 v131, v131, v5
  v_or_b32 v132, v132, v5
  v_or_b32 v133, v133, v5
  v_or_b32 v134, v134, v5
  v_or_b32 v135, v135, v5
  s_add_u32 s18, s31, 2048
  s_add_u32 s32, s12, s18
  s_addc_u32 s33, s13, 0
  global_store_dwordx4 v3, v[128:131], s[32:33]
  global_store_dwordx4 v3, v[132:135], s[32:33] offset:1024
  s_nop 1
  v_cvt_pk_bf16_f32 v128, v112, v113
  v_cvt_pk_bf16_f32 v129, v114, v115
  v_cvt_pk_bf16_f32 v130, v116, v117
  v_cvt_pk_bf16_f32 v131, v118, v119
  v_cvt_pk_bf16_f32 v132, v120, v121
  v_cvt_pk_bf16_f32 v133, v122, v123
  v_cvt_pk_bf16_f32 v134, v124, v125
  v_cvt_pk_bf16_f32 v135, v126, v127
  v_or_b32 v128, v128, v5
  v_or_b32 v129, v129, v5
  v_or_b32 v130, v130, v5
  v_or_b32 v131, v131, v5
  v_or_b32 v132, v132, v5
  v_or_b32 v133, v133, v5
  v_or_b32 v134, v134, v5
  v_or_b32 v135, v135, v5
  s_add_u32 s18, s31, 133120
  s_add_u32 s32, s12, s18
  s_addc_u32 s33, s13, 0
  global_store_dwordx4 v3, v[128:131], s[32:33]
  global_store_dwordx4 v3, v[132:135], s[32:33] offset:1024
  s_nop 1
  s_branch K1_end
K1_ffn:
  s_sub_u32 s15, s2, 192
  s_load_dwordx2 s[4:5], s[0:1], 40
  s_load_dwordx2 s[6:7], s[0:1], 48
  s_load_dwordx2 s[8:9], s[0:1], 56
  v_and_b32 v4, 3, v0
  v_lshrrev_b32 v5, 2, v0
  s_waitcnt lgkmcnt(0)
  v_mul_u32_u24 v6, 25088, v5
  v_lshl_add_u32 v6, v4, 4, v6
  s_lshl_b32 s16, s15, 6
  v_add_u32 v6, s16, v6
  s_add_u32 s20, s4, 0
  s_addc_u32 s21, s5, 0
  global_load_dwordx4 v[8:11], v6, s[20:21]
  s_add_u32 s22, s6, 0
  s_addc_u32 s23, s7, 0
  global_load_dwordx4 v[36:39], v6, s[22:23]
  s_add_u32 s20, s4, 3584
  s_addc_u32 s21, s5, 0
  global_load_dwordx4 v[12:15], v6, s[20:21]
  s_add_u32 s22, s6, 3584
  s_addc_u32 s23, s7, 0
  global_load_dwordx4 v[40:43], v6, s[22:23]
  s_add_u32 s20, s4, 7168
  s_addc_u32 s21, s5, 0
  global_load_dwordx4 v[16:19], v6, s[20:21]
  s_add_u32 s22, s6, 7168
  s_addc_u32 s23, s7, 0
  global_load_dwordx4 v[44:47], v6, s[22:23]
  s_add_u32 s20, s4, 10752
  s_addc_u32 s21, s5, 0
  global_load_dwordx4 v[20:23], v6, s[20:21]
  s_add_u32 s22, s6, 10752
  s_addc_u32 s23, s7, 0
  global_load_dwordx4 v[48:51], v6, s[22:23]
  s_add_u32 s20, s4, 14336
  s_addc_u32 s21, s5, 0
  global_load_dwordx4 v[24:27], v6, s[20:21]
  s_add_u32 s22, s6, 14336
  s_addc_u32 s23, s7, 0
  global_load_dwordx4 v[52:55], v6, s[22:23]
  s_add_u32 s20, s4, 17920
  s_addc_u32 s21, s5, 0
  global_load_dwordx4 v[28:31], v6, s[20:21]
  s_add_u32 s22, s6, 17920
  s_addc_u32 s23, s7, 0
  global_load_dwordx4 v[56:59], v6, s[22:23]
  s_add_u32 s20, s4, 21504
  s_addc_u32 s21, s5, 0
  global_load_dwordx4 v[32:35], v6, s[20:21]
  s_add_u32 s22, s6, 21504
  s_addc_u32 s23, s7, 0
  global_load_dwordx4 v[60:63], v6, s[22:23]
  v_mul_u32_u24 v7, 1171, v0
  v_lshrrev_b32 v7, 16, v7
  v_mul_u32_u24 v104, 56, v7
  v_sub_u32 v104, v0, v104
  v_lshlrev_b32 v105, 3, v7
  s_lshl_b32 s16, s15, 5
  v_add_u32 v105, s16, v105
  v_mul_u32_u24 v105, 896, v105
  v_lshl_add_u32 v105, v104, 4, v105
  v_cmp_gt_u32 vcc, 224, v0
  s_and_saveexec_b64 s[24:25], vcc
  s_add_u32 s20, s8, 3584
  s_addc_u32 s21, s9, 0
  global_load_dwordx4 v[64:67], v105, s[8:9] offset:0
  global_load_dwordx4 v[68:71], v105, s[8:9] offset:896
  global_load_dwordx4 v[72:75], v105, s[8:9] offset:1792
  global_load_dwordx4 v[76:79], v105, s[8:9] offset:2688
  global_load_dwordx4 v[80:83], v105, s[20:21] offset:0
  global_load_dwordx4 v[84:87], v105, s[20:21] offset:896
  global_load_dwordx4 v[88:91], v105, s[20:21] offset:1792
  global_load_dwordx4 v[92:95], v105, s[20:21] offset:2688
  s_mov_b64 exec, s[24:25]
  v_lshlrev_b32 v106, 5, v0
  s_add_u32 s20, s12, 3670016
  s_addc_u32 s21, s13, 0
  global_load_dwordx4 v[96:99], v106, s[20:21]
  global_load_dwordx4 v[100:103], v106, s[20:21] offset:16
  s_waitcnt vmcnt(0)
  v_max3_f32 v107, v96, v97, v98
  v_max3_f32 v107, v99, v100, v107
  v_max3_f32 v107, v101, v102, v107
  v_max_f32 v107, v103, v107
  s_nop 1
  v_max_f32_dpp v107, v107, v107 row_shr:1 row_mask:0xf bank_mask:0xf
  s_nop 1
  v_max_f32_dpp v107, v107, v107 row_shr:2 row_mask:0xf bank_mask:0xf
  s_nop 1
  v_max_f32_dpp v107, v107, v107 row_shr:4 row_mask:0xf bank_mask:0xf
  s_nop 1
  v_max_f32_dpp v107, v107, v107 row_shr:8 row_mask:0xf bank_mask:0xf
  s_nop 1
  v_max_f32_dpp v107, v107, v107 row_bcast:15 row_mask:0xa bank_mask:0xf
  s_nop 1
  v_max_f32_dpp v107, v107, v107 row_bcast:31 row_mask:0xc bank_mask:0xf
  s_nop 1
  v_readlane_b32 s16, v107, 63
  s_lshl_b32 s17, s14, 2
  v_mov_b32 v108, s16
  v_mov_b32 v109, s17
  ds_write_b32 v109, v108 offset:16384
  s_waitcnt lgkmcnt(0)
  s_barrier
  v_mov_b32 v109, 0
  ds_read_b128 v[108:111], v109 offset:16384
  s_waitcnt lgkmcnt(0)
  v_max3_f32 v107, v108, v109, v110
  v_max_f32 v107, v107, v111
  v_mov_b32 v108, -1
  v_lshlrev_b32 v109, 3, v0
  v_cmp_eq_f32 vcc, v103, v107
  v_add_u32 v110, 7, v109
  s_nop 0
  v_cndmask_b32 v108, v108, v110, vcc
  v_cmp_eq_f32 vcc, v102, v107
  v_add_u32 v110, 6, v109
  s_nop 0
  v_cndmask_b32 v108, v108, v110, vcc
  v_cmp_eq_f32 vcc, v101, v107
  v_add_u32 v110, 5, v109
  s_nop 0
  v_cndmask_b32 v108, v108, v110, vcc
  v_cmp_eq_f32 vcc, v100, v107
  v_add_u32 v110, 4, v109
  s_nop 0
  v_cndmask_b32 v108, v108, v110, vcc
  v_cmp_eq_f32 vcc, v99, v107
  v_add_u32 v110, 3, v109
  s_nop 0
  v_cndmask_b32 v108, v108, v110, vcc
  v_cmp_eq_f32 vcc, v98, v107
  v_add_u32 v110, 2, v109
  s_nop 0
  v_cndmask_b32 v108, v108, v110, vcc
  v_cmp_eq_f32 vcc, v97, v107
  v_add_u32 v110, 1, v109
  s_nop 0
  v_cndmask_b32 v108, v108, v110, vcc
  v_cmp_eq_f32 vcc, v96, v107
  v_add_u32 v110, 0, v109
  s_nop 0
  v_cndmask_b32 v108, v108, v110, vcc
  s_nop 1
  v_min_u32_dpp v108, v108, v108 row_shr:1 row_mask:0xf bank_mask:0xf
  s_nop 1
  v_min_u32_dpp v108, v108, v108 row_shr:2 row_mask:0xf bank_mask:0xf
  s_nop 1
  v_min_u32_dpp v108, v108, v108 row_shr:4 row_mask:0xf bank_mask:0xf
  s_nop 1
  v_min_u32_dpp v108, v108, v108 row_shr:8 row_mask:0xf bank_mask:0xf
  s_nop 1
  v_min_u32_dpp v108, v108, v108 row_bcast:15 row_mask:0xa bank_mask:0xf
  s_nop 1
  v_min_u32_dpp v108, v108, v108 row_bcast:31 row_mask:0xc bank_mask:0xf
  s_nop 1
  v_readlane_b32 s16, v108, 63
  s_lshl_b32 s17, s14, 2
  v_mov_b32 v108, s16
  v_mov_b32 v109, s17
  ds_write_b32 v109, v108 offset:16400
  s_waitcnt lgkmcnt(0)
  s_barrier
  v_mov_b32 v109, 0
  ds_read_b128 v[108:111], v109 offset:16400
  s_waitcnt lgkmcnt(0)
  v_min_u32 v108, v108, v109
  v_min3_u32 v108, v108, v110, v111
  s_nop 1
  v_readfirstlane_b32 s18, v108
  s_cmp_eq_u32 s15, 0
  s_cbranch_scc0 K1F_noidx
  s_add_u32 s20, s12, 14092032
  s_addc_u32 s21, s13, 0
  v_mov_b32 v109, 0
  s_mov_b64 exec, 1
  global_store_dword v109, v108, s[20:21]
  s_mov_b64 exec, -1
K1F_noidx:
  s_mul_i32 s16, s18, 896
  s_add_u32 s16, s16, 1835008
  s_add_u32 s20, s12, s16
  s_addc_u32 s21, s13, 0
  v_lshlrev_b32 v109, 2, v0
  v_cmp_gt_u32 vcc, 224, v0
  s_and_saveexec_b64 s[24:25], vcc
  global_load_dword v108, v109, s[20:21]
  s_waitcnt vmcnt(0)
  v_lshlrev_b32 v110, 16, v108
  v_and_b32 v111, 0xffff0000, v108
  v_lshlrev_b32 v109, 3, v0
  ds_write_b64 v109, v[110:111] offset:16448
  s_mov_b64 exec, s[24:25]
  s_waitcnt lgkmcnt(0)
  s_barrier
  v_mul_u32_u24 v109, 28, v5
  ds_read_b32 v112, v109 offset:16448
  ds_read_b32 v113, v109 offset:16452
  ds_read_b32 v114, v109 offset:16456
  ds_read_b32 v115, v109 offset:16460
  ds_read_b32 v116, v109 offset:16464
  ds_read_b32 v117, v109 offset:16468
  ds_read_b32 v118, v109 offset:16472
  v_mov_b32 v120, 0
  v_mov_b32 v121, 0
  v_mov_b32 v122, 0
  v_mov_b32 v123, 0
  v_mov_b32 v124, 0
  v_mov_b32 v125, 0
  v_mov_b32 v126, 0
  v_mov_b32 v127, 0
  v_mov_b32 v128, 0
  v_mov_b32 v129, 0
  v_mov_b32 v130, 0
  v_mov_b32 v131, 0
  v_mov_b32 v132, 0
  v_mov_b32 v133, 0
  v_mov_b32 v134, 0
  v_mov_b32 v135, 0
  s_waitcnt lgkmcnt(0)
  v_lshlrev_b32 v136, 16, v8
  v_and_b32 v137, 0xffff0000, v8
  v_fmac_f32 v120, v112, v136
  v_fmac_f32 v121, v112, v137
  v_lshlrev_b32 v136, 16, v9
  v_and_b32 v137, 0xffff0000, v9
  v_fmac_f32 v122, v112, v136
  v_fmac_f32 v123, v112, v137
  v_lshlrev_b32 v136, 16, v10
  v_and_b32 v137, 0xffff0000, v10
  v_fmac_f32 v124, v112, v136
  v_fmac_f32 v125, v112, v137
  v_lshlrev_b32 v136, 16, v11
  v_and_b32 v137, 0xffff0000, v11
  v_fmac_f32 v126, v112, v136
  v_fmac_f32 v127, v112, v137
  v_lshlrev_b32 v136, 16, v36
  v_and_b32 v137, 0xffff0000, v36
  v_fmac_f32 v128, v112, v136
  v_fmac_f32 v129, v112, v137
  v_lshlrev_b32 v136, 16, v37
  v_and_b32 v137, 0xffff0000, v37
  v_fmac_f32 v130, v112, v136
  v_fmac_f32 v131, v112, v137
  v_lshlrev_b32 v136, 16, v38
  v_and_b32 v137, 0xffff0000, v38
  v_fmac_f32 v132, v112, v136
  v_fmac_f32 v133, v112, v137
  v_lshlrev_b32 v136, 16, v39
  v_and_b32 v137, 0xffff0000, v39
  v_fmac_f32 v134, v112, v136
  v_fmac_f32 v135, v112, v137
  v_lshlrev_b32 v136, 16, v12
  v_and_b32 v137, 0xffff0000, v12
  v_fmac_f32 v120, v113, v136
  v_fmac_f32 v121, v113, v137
  v_lshlrev_b32 v136, 16, v13
  v_and_b32 v137, 0xffff0000, v13
  v_fmac_f32 v122, v113, v136
  v_fmac_f32 v123, v113, v137
  v_lshlrev_b32 v136, 16, v14
  v_and_b32 v137, 0xffff0000, v14
  v_fmac_f32 v124, v113, v136
  v_fmac_f32 v125, v113, v137
  v_lshlrev_b32 v136, 16, v15
  v_and_b32 v137, 0xffff0000, v15
  v_fmac_f32 v126, v113, v136
  v_fmac_f32 v127, v113, v137
  v_lshlrev_b32 v136, 16, v40
  v_and_b32 v137, 0xffff0000, v40
  v_fmac_f32 v128, v113, v136
  v_fmac_f32 v129, v113, v137
  v_lshlrev_b32 v136, 16, v41
  v_and_b32 v137, 0xffff0000, v41
  v_fmac_f32 v130, v113, v136
  v_fmac_f32 v131, v113, v137
  v_lshlrev_b32 v136, 16, v42
  v_and_b32 v137, 0xffff0000, v42
  v_fmac_f32 v132, v113, v136
  v_fmac_f32 v133, v113, v137
  v_lshlrev_b32 v136, 16, v43
  v_and_b32 v137, 0xffff0000, v43
  v_fmac_f32 v134, v113, v136
  v_fmac_f32 v135, v113, v137
  v_lshlrev_b32 v136, 16, v16
  v_and_b32 v137, 0xffff0000, v16
  v_fmac_f32 v120, v114, v136
  v_fmac_f32 v121, v114, v137
  v_lshlrev_b32 v136, 16, v17
  v_and_b32 v137, 0xffff0000, v17
  v_fmac_f32 v122, v114, v136
  v_fmac_f32 v123, v114, v137
  v_lshlrev_b32 v136, 16, v18
  v_and_b32 v137, 0xffff0000, v18
  v_fmac_f32 v124, v114, v136
  v_fmac_f32 v125, v114, v137
  v_lshlrev_b32 v136, 16, v19
  v_and_b32 v137, 0xffff0000, v19
  v_fmac_f32 v126, v114, v136
  v_fmac_f32 v127, v114, v137
  v_lshlrev_b32 v136, 16, v44
  v_and_b32 v137, 0xffff0000, v44
  v_fmac_f32 v128, v114, v136
  v_fmac_f32 v129, v114, v137
  v_lshlrev_b32 v136, 16, v45
  v_and_b32 v137, 0xffff0000, v45
  v_fmac_f32 v130, v114, v136
  v_fmac_f32 v131, v114, v137
  v_lshlrev_b32 v136, 16, v46
  v_and_b32 v137, 0xffff0000, v46
  v_fmac_f32 v132, v114, v136
  v_fmac_f32 v133, v114, v137
  v_lshlrev_b32 v136, 16, v47
  v_and_b32 v137, 0xffff0000, v47
  v_fmac_f32 v134, v114, v136
  v_fmac_f32 v135, v114, v137
  v_lshlrev_b32 v136, 16, v20
  v_and_b32 v137, 0xffff0000, v20
  v_fmac_f32 v120, v115, v136
  v_fmac_f32 v121, v115, v137
  v_lshlrev_b32 v136, 16, v21
  v_and_b32 v137, 0xffff0000, v21
  v_fmac_f32 v122, v115, v136
  v_fmac_f32 v123, v115, v137
  v_lshlrev_b32 v136, 16, v22
  v_and_b32 v137, 0xffff0000, v22
  v_fmac_f32 v124, v115, v136
  v_fmac_f32 v125, v115, v137
  v_lshlrev_b32 v136, 16, v23
  v_and_b32 v137, 0xffff0000, v23
  v_fmac_f32 v126, v115, v136
  v_fmac_f32 v127, v115, v137
  v_lshlrev_b32 v136, 16, v48
  v_and_b32 v137, 0xffff0000, v48
  v_fmac_f32 v128, v115, v136
  v_fmac_f32 v129, v115, v137
  v_lshlrev_b32 v136, 16, v49
  v_and_b32 v137, 0xffff0000, v49
  v_fmac_f32 v130, v115, v136
  v_fmac_f32 v131, v115, v137
  v_lshlrev_b32 v136, 16, v50
  v_and_b32 v137, 0xffff0000, v50
  v_fmac_f32 v132, v115, v136
  v_fmac_f32 v133, v115, v137
  v_lshlrev_b32 v136, 16, v51
  v_and_b32 v137, 0xffff0000, v51
  v_fmac_f32 v134, v115, v136
  v_fmac_f32 v135, v115, v137
  v_lshlrev_b32 v136, 16, v24
  v_and_b32 v137, 0xffff0000, v24
  v_fmac_f32 v120, v116, v136
  v_fmac_f32 v121, v116, v137
  v_lshlrev_b32 v136, 16, v25
  v_and_b32 v137, 0xffff0000, v25
  v_fmac_f32 v122, v116, v136
  v_fmac_f32 v123, v116, v137
  v_lshlrev_b32 v136, 16, v26
  v_and_b32 v137, 0xffff0000, v26
  v_fmac_f32 v124, v116, v136
  v_fmac_f32 v125, v116, v137
  v_lshlrev_b32 v136, 16, v27
  v_and_b32 v137, 0xffff0000, v27
  v_fmac_f32 v126, v116, v136
  v_fmac_f32 v127, v116, v137
  v_lshlrev_b32 v136, 16, v52
  v_and_b32 v137, 0xffff0000, v52
  v_fmac_f32 v128, v116, v136
  v_fmac_f32 v129, v116, v137
  v_lshlrev_b32 v136, 16, v53
  v_and_b32 v137, 0xffff0000, v53
  v_fmac_f32 v130, v116, v136
  v_fmac_f32 v131, v116, v137
  v_lshlrev_b32 v136, 16, v54
  v_and_b32 v137, 0xffff0000, v54
  v_fmac_f32 v132, v116, v136
  v_fmac_f32 v133, v116, v137
  v_lshlrev_b32 v136, 16, v55
  v_and_b32 v137, 0xffff0000, v55
  v_fmac_f32 v134, v116, v136
  v_fmac_f32 v135, v116, v137
  v_lshlrev_b32 v136, 16, v28
  v_and_b32 v137, 0xffff0000, v28
  v_fmac_f32 v120, v117, v136
  v_fmac_f32 v121, v117, v137
  v_lshlrev_b32 v136, 16, v29
  v_and_b32 v137, 0xffff0000, v29
  v_fmac_f32 v122, v117, v136
  v_fmac_f32 v123, v117, v137
  v_lshlrev_b32 v136, 16, v30
  v_and_b32 v137, 0xffff0000, v30
  v_fmac_f32 v124, v117, v136
  v_fmac_f32 v125, v117, v137
  v_lshlrev_b32 v136, 16, v31
  v_and_b32 v137, 0xffff0000, v31
  v_fmac_f32 v126, v117, v136
  v_fmac_f32 v127, v117, v137
  v_lshlrev_b32 v136, 16, v56
  v_and_b32 v137, 0xffff0000, v56
  v_fmac_f32 v128, v117, v136
  v_fmac_f32 v129, v117, v137
  v_lshlrev_b32 v136, 16, v57
  v_and_b32 v137, 0xffff0000, v57
  v_fmac_f32 v130, v117, v136
  v_fmac_f32 v131, v117, v137
  v_lshlrev_b32 v136, 16, v58
  v_and_b32 v137, 0xffff0000, v58
  v_fmac_f32 v132, v117, v136
  v_fmac_f32 v133, v117, v137
  v_lshlrev_b32 v136, 16, v59
  v_and_b32 v137, 0xffff0000, v59
  v_fmac_f32 v134, v117, v136
  v_fmac_f32 v135, v117, v137
  v_lshlrev_b32 v136, 16, v32
  v_and_b32 v137, 0xffff0000, v32
  v_fmac_f32 v120, v118, v136
  v_fmac_f32 v121, v118, v137
  v_lshlrev_b32 v136, 16, v33
  v_and_b32 v137, 0xffff0000, v33
  v_fmac_f32 v122, v118, v136
  v_fmac_f32 v123, v118, v137
  v_lshlrev_b32 v136, 16, v34
  v_and_b32 v137, 0xffff0000, v34
  v_fmac_f32 v124, v118, v136
  v_fmac_f32 v125, v118, v137
  v_lshlrev_b32 v136, 16, v35
  v_and_b32 v137, 0xffff0000, v35
  v_fmac_f32 v126, v118, v136
  v_fmac_f32 v127, v118, v137
  v_lshlrev_b32 v136, 16, v60
  v_and_b32 v137, 0xffff0000, v60
  v_fmac_f32 v128, v118, v136
  v_fmac_f32 v129, v118, v137
  v_lshlrev_b32 v136, 16, v61
  v_and_b32 v137, 0xffff0000, v61
  v_fmac_f32 v130, v118, v136
  v_fmac_f32 v131, v118, v137
  v_lshlrev_b32 v136, 16, v62
  v_and_b32 v137, 0xffff0000, v62
  v_fmac_f32 v132, v118, v136
  v_fmac_f32 v133, v118, v137
  v_lshlrev_b32 v136, 16, v63
  v_and_b32 v137, 0xffff0000, v63
  v_fmac_f32 v134, v118, v136
  v_fmac_f32 v135, v118, v137
  v_lshlrev_b32 v109, 12, v4
  v_lshl_add_u32 v109, v5, 6, v109
  ds_write_b128 v109, v[120:123] offset:0
  ds_write_b128 v109, v[124:127] offset:16
  ds_write_b128 v109, v[128:131] offset:32
  ds_write_b128 v109, v[132:135] offset:48
  s_waitcnt lgkmcnt(0)
  s_barrier
  v_lshrrev_b32 v109, 6, v0
  v_lshlrev_b32 v109, 12, v109
  v_bfe_u32 v110, v0, 4, 2
  v_lshl_add_u32 v109, v110, 10, v109
  v_and_b32 v110, 15, v0
  v_lshl_add_u32 v109, v110, 2, v109
  ds_read_b32 v120, v109 offset:0
  ds_read_b32 v121, v109 offset:64
  ds_read_b32 v122, v109 offset:128
  ds_read_b32 v123, v109 offset:192
  ds_read_b32 v124, v109 offset:256
  ds_read_b32 v125, v109 offset:320
  ds_read_b32 v126, v109 offset:384
  ds_read_b32 v127, v109 offset:448
  ds_read_b32 v128, v109 offset:512
  ds_read_b32 v129, v109 offset:576
  ds_read_b32 v130, v109 offset:640
  ds_read_b32 v131, v109 offset:704
  ds_read_b32 v132, v109 offset:768
  ds_read_b32 v133, v109 offset:832
  ds_read_b32 v134, v109 offset:896
  ds_read_b32 v135, v109 offset:960
  s_waitcnt lgkmcnt(0)
  v_add_f32 v120, v120, v121
  v_add_f32 v120, v120, v122
  v_add_f32 v120, v120, v123
  v_add_f32 v120, v120, v124
  v_add_f32 v120, v120, v125
  v_add_f32 v120, v120, v126
  v_add_f32 v120, v120, v127
  v_add_f32 v120, v120, v128
  v_add_f32 v120, v120, v129
  v_add_f32 v120, v120, v130
  v_add_f32 v120, v120, v131
  v_add_f32 v120, v120, v132
  v_add_f32 v120, v120, v133
  v_add_f32 v120, v120, v134
  v_add_f32 v120, v120, v135
  v_lshlrev_b32 v109, 2, v0
  ds_write_b32 v109, v120 offset:17408
  s_waitcnt lgkmcnt(0)
  s_barrier
  v_lshrrev_b32 v109, 3, v0
  v_lshlrev_b32 v109, 8, v109
  v_and_b32 v110, 7, v0
  v_lshl_add_u32 v109, v110, 2, v109
  v_cmp_gt_u32 vcc, 32, v0
  s_and_saveexec_b64 s[24:25], vcc
  ds_read_b32 v120, v109 offset:17408
  ds_read_b32 v124, v109 offset:17440
  ds_read_b32 v121, v109 offset:17472
  ds_read_b32 v125, v109 offset:17504
  ds_read_b32 v122, v109 offset:17536
  ds_read_b32 v126, v109 offset:17568
  ds_read_b32 v123, v109 offset:17600
  ds_read_b32 v127, v109 offset:17632
  s_waitcnt lgkmcnt(0)
  v_add_f32 v120, v120, v121
  v_add_f32 v122, v122, v123
  v_add_f32 v120, v120, v122
  v_add_f32 v124, v124, v125
  v_add_f32 v126, v126, v127
  v_add_f32 v124, v124, v126
  v_cvt_pk_bf16_f32 v120, v120, v124
  v_and_b32 v124, 0xffff0000, v120
  v_lshlrev_b32 v120, 16, v120
  v_mul_f32 v121, 0xbfb8aa3b, v120
  v_exp_f32 v121, v121
  s_nop 0
  v_add_f32 v121, 1.0, v121
  v_rcp_f32 v122, v121
  s_nop 0
  v_mul_f32 v120, v120, v122
  v_cvt_pk_bf16_f32 v120, v120, v120
  v_lshlrev_b32 v120, 16, v120
  v_mul_f32 v120, v120, v124
  v_cvt_pk_bf16_f32 v120, v120, v120
  v_lshlrev_b32 v120, 16, v120
  v_lshlrev_b32 v109, 2, v0
  ds_write_b32 v109, v120 offset:18432
  s_mov_b64 exec, s[24:25]
  s_waitcnt lgkmcnt(0)
  s_barrier
  v_lshlrev_b32 v109, 5, v7
  ds_read_b128 v[112:115], v109 offset:18432
  ds_read_b128 v[116:119], v109 offset:18448
  v_mov_b32 v120, 0
  v_mov_b32 v121, 0
  v_mov_b32 v122, 0
  v_mov_b32 v123, 0
  v_mov_b32 v124, 0
  v_mov_b32 v125, 0
  v_mov_b32 v126, 0
  v_mov_b32 v127, 0
  s_waitcnt vmcnt(0) lgkmcnt(0)
  v_lshlrev_b32 v136, 16, v64
  v_and_b32 v137, 0xffff0000, v64
  v_fmac_f32 v120, v112, v136
  v_fmac_f32 v121, v112, v137
  v_lshlrev_b32 v136, 16, v65
  v_and_b32 v137, 0xffff0000, v65
  v_fmac_f32 v122, v112, v136
  v_fmac_f32 v123, v112, v137
  v_lshlrev_b32 v136, 16, v66
  v_and_b32 v137, 0xffff0000, v66
  v_fmac_f32 v124, v112, v136
  v_fmac_f32 v125, v112, v137
  v_lshlrev_b32 v136, 16, v67
  v_and_b32 v137, 0xffff0000, v67
  v_fmac_f32 v126, v112, v136
  v_fmac_f32 v127, v112, v137
  v_lshlrev_b32 v136, 16, v68
  v_and_b32 v137, 0xffff0000, v68
  v_fmac_f32 v120, v113, v136
  v_fmac_f32 v121, v113, v137
  v_lshlrev_b32 v136, 16, v69
  v_and_b32 v137, 0xffff0000, v69
  v_fmac_f32 v122, v113, v136
  v_fmac_f32 v123, v113, v137
  v_lshlrev_b32 v136, 16, v70
  v_and_b32 v137, 0xffff0000, v70
  v_fmac_f32 v124, v113, v136
  v_fmac_f32 v125, v113, v137
  v_lshlrev_b32 v136, 16, v71
  v_and_b32 v137, 0xffff0000, v71
  v_fmac_f32 v126, v113, v136
  v_fmac_f32 v127, v113, v137
  v_lshlrev_b32 v136, 16, v72
  v_and_b32 v137, 0xffff0000, v72
  v_fmac_f32 v120, v114, v136
  v_fmac_f32 v121, v114, v137
  v_lshlrev_b32 v136, 16, v73
  v_and_b32 v137, 0xffff0000, v73
  v_fmac_f32 v122, v114, v136
  v_fmac_f32 v123, v114, v137
  v_lshlrev_b32 v136, 16, v74
  v_and_b32 v137, 0xffff0000, v74
  v_fmac_f32 v124, v114, v136
  v_fmac_f32 v125, v114, v137
  v_lshlrev_b32 v136, 16, v75
  v_and_b32 v137, 0xffff0000, v75
  v_fmac_f32 v126, v114, v136
  v_fmac_f32 v127, v114, v137
  v_lshlrev_b32 v136, 16, v76
  v_and_b32 v137, 0xffff0000, v76
  v_fmac_f32 v120, v115, v136
  v_fmac_f32 v121, v115, v137
  v_lshlrev_b32 v136, 16, v77
  v_and_b32 v137, 0xffff0000, v77
  v_fmac_f32 v122, v115, v136
  v_fmac_f32 v123, v115, v137
  v_lshlrev_b32 v136, 16, v78
  v_and_b32 v137, 0xffff0000, v78
  v_fmac_f32 v124, v115, v136
  v_fmac_f32 v125, v115, v137
  v_lshlrev_b32 v136, 16, v79
  v_and_b32 v137, 0xffff0000, v79
  v_fmac_f32 v126, v115, v136
  v_fmac_f32 v127, v115, v137
  v_lshlrev_b32 v136, 16, v80
  v_and_b32 v137, 0xffff0000, v80
  v_fmac_f32 v120, v116, v136
  v_fmac_f32 v121, v116, v137
  v_lshlrev_b32 v136, 16, v81
  v_and_b32 v137, 0xffff0000, v81
  v_fmac_f32 v122, v116, v136
  v_fmac_f32 v123, v116, v137
  v_lshlrev_b32 v136, 16, v82
  v_and_b32 v137, 0xffff0000, v82
  v_fmac_f32 v124, v116, v136
  v_fmac_f32 v125, v116, v137
  v_lshlrev_b32 v136, 16, v83
  v_and_b32 v137, 0xffff0000, v83
  v_fmac_f32 v126, v116, v136
  v_fmac_f32 v127, v116, v137
  v_lshlrev_b32 v136, 16, v84
  v_and_b32 v137, 0xffff0000, v84
  v_fmac_f32 v120, v117, v136
  v_fmac_f32 v121, v117, v137
  v_lshlrev_b32 v136, 16, v85
  v_and_b32 v137, 0xffff0000, v85
  v_fmac_f32 v122, v117, v136
  v_fmac_f32 v123, v117, v137
  v_lshlrev_b32 v136, 16, v86
  v_and_b32 v137, 0xffff0000, v86
  v_fmac_f32 v124, v117, v136
  v_fmac_f32 v125, v117, v137
  v_lshlrev_b32 v136, 16, v87
  v_and_b32 v137, 0xffff0000, v87
  v_fmac_f32 v126, v117, v136
  v_fmac_f32 v127, v117, v137
  v_lshlrev_b32 v136, 16, v88
  v_and_b32 v137, 0xffff0000, v88
  v_fmac_f32 v120, v118, v136
  v_fmac_f32 v121, v118, v137
  v_lshlrev_b32 v136, 16, v89
  v_and_b32 v137, 0xffff0000, v89
  v_fmac_f32 v122, v118, v136
  v_fmac_f32 v123, v118, v137
  v_lshlrev_b32 v136, 16, v90
  v_and_b32 v137, 0xffff0000, v90
  v_fmac_f32 v124, v118, v136
  v_fmac_f32 v125, v118, v137
  v_lshlrev_b32 v136, 16, v91
  v_and_b32 v137, 0xffff0000, v91
  v_fmac_f32 v126, v118, v136
  v_fmac_f32 v127, v118, v137
  v_lshlrev_b32 v136, 16, v92
  v_and_b32 v137, 0xffff0000, v92
  v_fmac_f32 v120, v119, v136
  v_fmac_f32 v121, v119, v137
  v_lshlrev_b32 v136, 16, v93
  v_and_b32 v137, 0xffff0000, v93
  v_fmac_f32 v122, v119, v136
  v_fmac_f32 v123, v119, v137
  v_lshlrev_b32 v136, 16, v94
  v_and_b32 v137, 0xffff0000, v94
  v_fmac_f32 v124, v119, v136
  v_fmac_f32 v125, v119, v137
  v_lshlrev_b32 v136, 16, v95
  v_and_b32 v137, 0xffff0000, v95
  v_fmac_f32 v126, v119, v136
  v_fmac_f32 v127, v119, v137
  v_mul_u32_u24 v109, 1792, v7
  v_lshl_add_u32 v109, v104, 5, v109
  v_cmp_gt_u32 vcc, 224, v0
  s_and_saveexec_b64 s[24:25], vcc
  ds_write_b128 v109, v[120:123]
  ds_write_b128 v109, v[124:127] offset:16
  s_mov_b64 exec, s[24:25]
  s_waitcnt lgkmcnt(0)
  s_barrier
  v_lshlrev_b32 v109, 4, v0
  v_cmp_gt_u32 vcc, 112, v0
  s_and_saveexec_b64 s[24:25], vcc
  ds_read_b128 v[120:123], v109 offset:0
  ds_read_b128 v[124:127], v109 offset:1792
  ds_read_b128 v[128:131], v109 offset:3584
  ds_read_b128 v[132:135], v109 offset:5376
  s_waitcnt lgkmcnt(0)
  v_add_f32 v120, v120, v124
  v_add_f32 v128, v128, v132
  v_add_f32 v120, v120, v128
  v_add_f32 v121, v121, v125
  v_add_f32 v129, v129, v133
  v_add_f32 v121, v121, v129
  v_add_f32 v122, v122, v126
  v_add_f32 v130, v130, v134
  v_add_f32 v122, v122, v130
  v_add_f32 v123, v123, v127
  v_add_f32 v131, v131, v135
  v_add_f32 v123, v123, v131
  s_mul_i32 s16, s15, 1792
  s_add_u32 s16, s16, 13959168
  s_add_u32 s20, s12, s16
  s_addc_u32 s21, s13, 0
  global_store_dwordx4 v109, v[120:123], s[20:21]
  s_mov_b64 exec, s[24:25]
K1_end:
  s_endpgm
.globl k2_attn_kernel
.p2align 8
.type k2_attn_kernel,@function
k2_attn_kernel:
  s_cmp_ge_u32 s2, 513
  s_cbranch_scc1 K2_end
  s_load_dwordx2 s[12:13], s[0:1], 80
  v_lshrrev_b32 v1, 6, v0
  v_and_b32 v2, 63, v0
  v_lshlrev_b32 v3, 4, v2
  v_readfirstlane_b32 s14, v1
  s_cmp_ge_u32 s2, 512
  s_cbranch_scc1 K2_red
  s_and_b32 s15, s2, 7
  s_lshl_b32 s15, s15, 1
  s_lshr_b32 s16, s2, 3
  s_and_b32 s16, s16, 1
  s_add_u32 s15, s15, s16
  s_lshr_b32 s16, s2, 4
  s_waitcnt lgkmcnt(0)
  s_lshl_b32 s17, s15, 6
  s_lshl_b32 s18, s16, 1
  s_add_u32 s17, s17, s18
  s_lshl_b32 s17, s17, 11
  s_add_u32 s17, s17, 5570560
  s_add_u32 s20, s12, s17
  s_addc_u32 s21, s13, 0
  global_load_dwordx4 v[8:11], v3, s[20:21]
  global_load_dwordx4 v[12:15], v3, s[20:21] offset:1024
  global_load_dwordx4 v[16:19], v3, s[20:21] offset:2048
  global_load_dwordx4 v[20:23], v3, s[20:21] offset:3072
  s_lshl_b32 s17, s15, 6
  s_lshl_b32 s18, s14, 4
  s_add_u32 s17, s17, s18
  s_lshl_b32 s17, s17, 11
  s_add_u32 s18, s17, 7667712
  s_add_u32 s22, s12, s18
  s_addc_u32 s23, s13, 0
  s_add_u32 s18, s17, 9764864
  s_add_u32 s24, s12, s18
  s_addc_u32 s25, s13, 0
  global_load_dwordx4 v[24:27], v3, s[22:23]
  global_load_dwordx4 v[28:31], v3, s[22:23] offset:1024
  s_add_u32 s22, s22, 2048
  s_addc_u32 s23, s23, 0
  global_load_dwordx4 v[32:35], v3, s[22:23]
  global_load_dwordx4 v[36:39], v3, s[22:23] offset:1024
  s_add_u32 s22, s22, 2048
  s_addc_u32 s23, s23, 0
  global_load_dwordx4 v[40:43], v3, s[22:23]
  global_load_dwordx4 v[44:47], v3, s[22:23] offset:1024
  s_add_u32 s22, s22, 2048
  s_addc_u32 s23, s23, 0
  global_load_dwordx4 v[48:51], v3, s[22:23]
  global_load_dwordx4 v[52:55], v3, s[22:23] offset:1024
  s_add_u32 s22, s22, 2048
  s_addc_u32 s23, s23, 0
  s_waitcnt vmcnt(8)
  v_mov_b32 v138, 0xff800000
  v_mov_b32 v139, 0xff800000
  s_waitcnt vmcnt(6)
  v_mfma_f32_32x32x16_bf16 v[72:87], v[24:27], v[8:11], 0
  v_mfma_f32_32x32x16_bf16 v[72:87], v[28:31], v[12:15], v[72:87]
  v_mfma_f32_32x32x16_bf16 v[88:103], v[24:27], v[16:19], 0
  v_mfma_f32_32x32x16_bf16 v[88:103], v[28:31], v[20:23], v[88:103]
  global_load_dwordx4 v[56:59], v3, s[24:25]
  global_load_dwordx4 v[60:63], v3, s[24:25] offset:1024
  s_add_u32 s24, s24, 2048
  s_addc_u32 s25, s25, 0
  s_nop 9
  v_max3_f32 v138, v72, v73, v138
  v_max3_f32 v138, v74, v75, v138
  v_max3_f32 v138, v76, v77, v138
  v_max3_f32 v138, v78, v79, v138
  v_max3_f32 v138, v80, v81, v138
  v_max3_f32 v138, v82, v83, v138
  v_max3_f32 v138, v84, v85, v138
  v_max3_f32 v138, v86, v87, v138
  s_waitcnt vmcnt(6)
  v_mfma_f32_32x32x16_bf16 v[72:87], v[32:35], v[8:11], 0
  v_mfma_f32_32x32x16_bf16 v[72:87], v[36:39], v[12:15], v[72:87]
  global_load_dwordx4 v[64:67], v3, s[24:25]
  global_load_dwordx4 v[68:71], v3, s[24:25] offset:1024
  s_add_u32 s24, s24, 2048
  s_addc_u32 s25, s25, 0
  s_nop 1
  v_max3_f32 v139, v88, v89, v139
  v_max3_f32 v139, v90, v91, v139
  v_max3_f32 v139, v92, v93, v139
  v_max3_f32 v139, v94, v95, v139
  v_max3_f32 v139, v96, v97, v139
  v_max3_f32 v139, v98, v99, v139
  v_max3_f32 v139, v100, v101, v139
  v_max3_f32 v139, v102, v103, v139
  v_mfma_f32_32x32x16_bf16 v[88:103], v[32:35], v[16:19], 0
  v_mfma_f32_32x32x16_bf16 v[88:103], v[36:39], v[20:23], v[88:103]
  s_nop 1
  v_max3_f32 v138, v72, v73, v138
  v_max3_f32 v138, v74, v75, v138
  v_max3_f32 v138, v76, v77, v138
  v_max3_f32 v138, v78, v79, v138
  v_max3_f32 v138, v80, v81, v138
  v_max3_f32 v138, v82, v83, v138
  v_max3_f32 v138, v84, v85, v138
  v_max3_f32 v138, v86, v87, v138
  s_waitcnt vmcnt(6)
  v_mfma_f32_32x32x16_bf16 v[72:87], v[40:43], v[8:11], 0
  v_mfma_f32_32x32x16_bf16 v[72:87], v[44:47], v[12:15], v[72:87]
  s_nop 1
  v_max3_f32 v139, v88, v89, v139
  v_max3_f32 v139, v90, v91, v139
  v_max3_f32 v139, v92, v93, v139
  v_max3_f32 v139, v94, v95, v139
  v_max3_f32 v139, v96, v97, v139
  v_max3_f32 v139, v98, v99, v139
  v_max3_f32 v139, v100, v101, v139
  v_max3_f32 v139, v102, v103, v139
  v_mfma_f32_32x32x16_bf16 v[88:103], v[40:43], v[16:19], 0
  v_mfma_f32_32x32x16_bf16 v[88:103], v[44:47], v[20:23], v[88:103]
  s_nop 1
  v_max3_f32 v138, v72, v73, v138
  v_max3_f32 v138, v74, v75, v138
  v_max3_f32 v138, v76, v77, v138
  v_max3_f32 v138, v78, v79, v138
  v_max3_f32 v138, v80, v81, v138
  v_max3_f32 v138, v82, v83, v138
  v_max3_f32 v138, v84, v85, v138
  v_max3_f32 v138, v86, v87, v138
  s_waitcnt vmcnt(4)
  v_mfma_f32_32x32x16_bf16 v[72:87], v[48:51], v[8:11], 0
  v_mfma_f32_32x32x16_bf16 v[72:87], v[52:55], v[12:15], v[72:87]
  s_nop 1
  v_max3_f32 v139, v88, v89, v139
  v_max3_f32 v139, v90, v91, v139
  v_max3_f32 v139, v92, v93, v139
  v_max3_f32 v139, v94, v95, v139
  v_max3_f32 v139, v96, v97, v139
  v_max3_f32 v139, v98, v99, v139
  v_max3_f32 v139, v100, v101, v139
  v_max3_f32 v139, v102, v103, v139
  v_mfma_f32_32x32x16_bf16 v[88:103], v[48:51], v[16:19], 0
  v_mfma_f32_32x32x16_bf16 v[88:103], v[52:55], v[20:23], v[88:103]
  s_nop 1
  v_max3_f32 v138, v72, v73, v138
  v_max3_f32 v138, v74, v75, v138
  v_max3_f32 v138, v76, v77, v138
  v_max3_f32 v138, v78, v79, v138
  v_max3_f32 v138, v80, v81, v138
  v_max3_f32 v138, v82, v83, v138
  v_max3_f32 v138, v84, v85, v138
  v_max3_f32 v138, v86, v87, v138
  s_nop 3
  v_max3_f32 v139, v88, v89, v139
  v_max3_f32 v139, v90, v91, v139
  v_max3_f32 v139, v92, v93, v139
  v_max3_f32 v139, v94, v95, v139
  v_max3_f32 v139, v96, v97, v139
  v_max3_f32 v139, v98, v99, v139
  v_max3_f32 v139, v100, v101, v139
  v_max3_f32 v139, v102, v103, v139
  v_mov_b32 v140, v138
  v_mov_b32 v144, v139
  s_nop 0
  v_permlane32_swap_b32 v138, v140
  v_permlane32_swap_b32 v139, v144
  s_nop 0
  v_max_f32 v138, v138, v140
  v_max_f32 v139, v139, v144
  v_mov_b32 v136, v138
  v_mov_b32 v137, v139
  v_sub_f32 v140, 0, v136
  v_sub_f32 v144, 0, v137
  v_cvt_pk_bf16_f32 v141, v140, v140
  v_cvt_pk_bf16_f32 v145, v144, v144
  v_lshlrev_b32 v141, 16, v141
  v_lshlrev_b32 v145, 16, v145
  v_sub_f32 v142, v140, v141
  v_sub_f32 v146, v144, v145
  v_cvt_pk_bf16_f32 v141, v142, v142
  v_cvt_pk_bf16_f32 v145, v146, v146
  v_lshlrev_b32 v141, 16, v141
  v_lshlrev_b32 v145, 16, v145
  v_sub_f32 v143, v142, v141
  v_sub_f32 v147, v146, v145
  s_mov_b32 exec_lo, 0
  v_cvt_pk_bf16_f32 v14, v140, v142
  v_cvt_pk_bf16_f32 v15, v143, 0
  v_cvt_pk_bf16_f32 v22, v144, v146
  v_cvt_pk_bf16_f32 v23, v147, 0
  s_mov_b32 exec_lo, -1
  s_nop 3
  v_mfma_f32_32x32x16_bf16 v[72:87], v[24:27], v[8:11], 0
  v_mfma_f32_32x32x16_bf16 v[72:87], v[28:31], v[12:15], v[72:87]
  s_nop 10
  v_mfma_f32_32x32x16_bf16 v[88:103], v[24:27], v[16:19], 0
  v_exp_f32 v72, v72
  v_exp_f32 v73, v73
  v_exp_f32 v74, v74
  v_exp_f32 v75, v75
  v_cvt_pk_bf16_f32 v148, v72, v73
  v_cvt_pk_bf16_f32 v149, v74, v75
  v_mfma_f32_32x32x16_bf16 v[88:103], v[28:31], v[20:23], v[88:103]
  global_load_dwordx4 v[24:27], v3, s[22:23]
  global_load_dwordx4 v[28:31], v3, s[22:23] offset:1024
  s_add_u32 s22, s22, 2048
  s_addc_u32 s23, s23, 0
  v_exp_f32 v76, v76
  v_exp_f32 v77, v77
  v_exp_f32 v78, v78
  v_exp_f32 v79, v79
  v_cvt_pk_bf16_f32 v150, v76, v77
  v_cvt_pk_bf16_f32 v151, v78, v79
  v_exp_f32 v80, v80
  v_exp_f32 v81, v81
  v_exp_f32 v82, v82
  v_exp_f32 v83, v83
  v_cvt_pk_bf16_f32 v152, v80, v81
  v_cvt_pk_bf16_f32 v153, v82, v83
  v_exp_f32 v84, v84
  v_exp_f32 v85, v85
  v_exp_f32 v86, v86
  v_exp_f32 v87, v87
  v_cvt_pk_bf16_f32 v154, v84, v85
  v_cvt_pk_bf16_f32 v155, v86, v87
  v_mfma_f32_32x32x16_bf16 v[72:87], v[32:35], v[8:11], 0
  v_exp_f32 v88, v88
  v_exp_f32 v89, v89
  v_exp_f32 v90, v90
  v_exp_f32 v91, v91
  v_cvt_pk_bf16_f32 v156, v88, v89
  v_cvt_pk_bf16_f32 v157, v90, v91
  v_mfma_f32_32x32x16_bf16 v[72:87], v[36:39], v[12:15], v[72:87]
  v_exp_f32 v92, v92
  v_exp_f32 v93, v93
  v_exp_f32 v94, v94
  v_exp_f32 v95, v95
  v_cvt_pk_bf16_f32 v158, v92, v93
  v_cvt_pk_bf16_f32 v159, v94, v95
  s_waitcnt vmcnt(4)
  v_mfma_f32_32x32x16_bf16 v[104:119], v[56:59], v[148:151], 0
  v_exp_f32 v96, v96
  v_exp_f32 v97, v97
  v_exp_f32 v98, v98
  v_exp_f32 v99, v99
  v_cvt_pk_bf16_f32 v160, v96, v97
  v_cvt_pk_bf16_f32 v161, v98, v99
  v_mfma_f32_32x32x16_bf16 v[104:119], v[60:63], v[152:155], v[104:119]
  v_exp_f32 v100, v100
  v_exp_f32 v101, v101
  v_exp_f32 v102, v102
  v_exp_f32 v103, v103
  v_cvt_pk_bf16_f32 v162, v100, v101
  v_cvt_pk_bf16_f32 v163, v102, v103
  v_mfma_f32_32x32x16_bf16 v[88:103], v[32:35], v[16:19], 0
  v_exp_f32 v72, v72
  v_exp_f32 v73, v73
  v_exp_f32 v74, v74
  v_exp_f32 v75, v75
  v_cvt_pk_bf16_f32 v148, v72, v73
  v_cvt_pk_bf16_f32 v149, v74, v75
  v_mfma_f32_32x32x16_bf16 v[88:103], v[36:39], v[20:23], v[88:103]
  global_load_dwordx4 v[32:35], v3, s[22:23]
  global_load_dwordx4 v[36:39], v3, s[22:23] offset:1024
  s_add_u32 s22, s22, 2048
  s_addc_u32 s23, s23, 0
  v_exp_f32 v76, v76
  v_exp_f32 v77, v77
  v_exp_f32 v78, v78
  v_exp_f32 v79, v79
  v_cvt_pk_bf16_f32 v150, v76, v77
  v_cvt_pk_bf16_f32 v151, v78, v79
  v_mfma_f32_32x32x16_bf16 v[120:135], v[56:59], v[156:159], 0
  v_exp_f32 v80, v80
  v_exp_f32 v81, v81
  v_exp_f32 v82, v82
  v_exp_f32 v83, v83
  v_cvt_pk_bf16_f32 v152, v80, v81
  v_cvt_pk_bf16_f32 v153, v82, v83
  v_mfma_f32_32x32x16_bf16 v[120:135], v[60:63], v[160:163], v[120:135]
  global_load_dwordx4 v[56:59], v3, s[24:25]
  global_load_dwordx4 v[60:63], v3, s[24:25] offset:1024
  s_add_u32 s24, s24, 2048
  s_addc_u32 s25, s25, 0
  v_exp_f32 v84, v84
  v_exp_f32 v85, v85
  v_exp_f32 v86, v86
  v_exp_f32 v87, v87
  v_cvt_pk_bf16_f32 v154, v84, v85
  v_cvt_pk_bf16_f32 v155, v86, v87
  v_mfma_f32_32x32x16_bf16 v[72:87], v[40:43], v[8:11], 0
  v_exp_f32 v88, v88
  v_exp_f32 v89, v89
  v_exp_f32 v90, v90
  v_exp_f32 v91, v91
  v_cvt_pk_bf16_f32 v156, v88, v89
  v_cvt_pk_bf16_f32 v157, v90, v91
  v_mfma_f32_32x32x16_bf16 v[72:87], v[44:47], v[12:15], v[72:87]
  v_exp_f32 v92, v92
  v_exp_f32 v93, v93
  v_exp_f32 v94, v94
  v_exp_f32 v95, v95
  v_cvt_pk_bf16_f32 v158, v92, v93
  v_cvt_pk_bf16_f32 v159, v94, v95
  s_waitcnt vmcnt(6)
  v_mfma_f32_32x32x16_bf16 v[104:119], v[64:67], v[148:151], v[104:119]
  v_exp_f32 v96, v96
  v_exp_f32 v97, v97
  v_exp_f32 v98, v98
  v_exp_f32 v99, v99
  v_cvt_pk_bf16_f32 v160, v96, v97
  v_cvt_pk_bf16_f32 v161, v98, v99
  v_mfma_f32_32x32x16_bf16 v[104:119], v[68:71], v[152:155], v[104:119]
  v_exp_f32 v100, v100
  v_exp_f32 v101, v101
  v_exp_f32 v102, v102
  v_exp_f32 v103, v103
  v_cvt_pk_bf16_f32 v162, v100, v101
  v_cvt_pk_bf16_f32 v163, v102, v103
  v_mfma_f32_32x32x16_bf16 v[88:103], v[40:43], v[16:19], 0
  v_exp_f32 v72, v72
  v_exp_f32 v73, v73
  v_exp_f32 v74, v74
  v_exp_f32 v75, v75
  v_cvt_pk_bf16_f32 v148, v72, v73
  v_cvt_pk_bf16_f32 v149, v74, v75
  v_mfma_f32_32x32x16_bf16 v[88:103], v[44:47], v[20:23], v[88:103]
  global_load_dwordx4 v[40:43], v3, s[22:23]
  global_load_dwordx4 v[44:47], v3, s[22:23] offset:1024
  s_add_u32 s22, s22, 2048
  s_addc_u32 s23, s23, 0
  v_exp_f32 v76, v76
  v_exp_f32 v77, v77
  v_exp_f32 v78, v78
  v_exp_f32 v79, v79
  v_cvt_pk_bf16_f32 v150, v76, v77
  v_cvt_pk_bf16_f32 v151, v78, v79
  v_mfma_f32_32x32x16_bf16 v[120:135], v[64:67], v[156:159], v[120:135]
  v_exp_f32 v80, v80
  v_exp_f32 v81, v81
  v_exp_f32 v82, v82
  v_exp_f32 v83, v83
  v_cvt_pk_bf16_f32 v152, v80, v81
  v_cvt_pk_bf16_f32 v153, v82, v83
  v_mfma_f32_32x32x16_bf16 v[120:135], v[68:71], v[160:163], v[120:135]
  global_load_dwordx4 v[64:67], v3, s[24:25]
  global_load_dwordx4 v[68:71], v3, s[24:25] offset:1024
  s_add_u32 s24, s24, 2048
  s_addc_u32 s25, s25, 0
  v_exp_f32 v84, v84
  v_exp_f32 v85, v85
  v_exp_f32 v86, v86
  v_exp_f32 v87, v87
  v_cvt_pk_bf16_f32 v154, v84, v85
  v_cvt_pk_bf16_f32 v155, v86, v87
  v_mfma_f32_32x32x16_bf16 v[72:87], v[48:51], v[8:11], 0
  v_exp_f32 v88, v88
  v_exp_f32 v89, v89
  v_exp_f32 v90, v90
  v_exp_f32 v91, v91
  v_cvt_pk_bf16_f32 v156, v88, v89
  v_cvt_pk_bf16_f32 v157, v90, v91
  v_mfma_f32_32x32x16_bf16 v[72:87], v[52:55], v[12:15], v[72:87]
  v_exp_f32 v92, v92
  v_exp_f32 v93, v93
  v_exp_f32 v94, v94
  v_exp_f32 v95, v95
  v_cvt_pk_bf16_f32 v158, v92, v93
  v_cvt_pk_bf16_f32 v159, v94, v95
  s_waitcnt vmcnt(4)
  v_mfma_f32_32x32x16_bf16 v[104:119], v[56:59], v[148:151], v[104:119]
  v_exp_f32 v96, v96
  v_exp_f32 v97, v97
  v_exp_f32 v98, v98
  v_exp_f32 v99, v99
  v_cvt_pk_bf16_f32 v160, v96, v97
  v_cvt_pk_bf16_f32 v161, v98, v99
  v_mfma_f32_32x32x16_bf16 v[104:119], v[60:63], v[152:155], v[104:119]
  v_exp_f32 v100, v100
  v_exp_f32 v101, v101
  v_exp_f32 v102, v102
  v_exp_f32 v103, v103
  v_cvt_pk_bf16_f32 v162, v100, v101
  v_cvt_pk_bf16_f32 v163, v102, v103
  v_mfma_f32_32x32x16_bf16 v[88:103], v[48:51], v[16:19], 0
  v_exp_f32 v72, v72
  v_exp_f32 v73, v73
  v_exp_f32 v74, v74
  v_exp_f32 v75, v75
  v_cvt_pk_bf16_f32 v148, v72, v73
  v_cvt_pk_bf16_f32 v149, v74, v75
  v_mfma_f32_32x32x16_bf16 v[88:103], v[52:55], v[20:23], v[88:103]
  global_load_dwordx4 v[48:51], v3, s[22:23]
  global_load_dwordx4 v[52:55], v3, s[22:23] offset:1024
  s_add_u32 s22, s22, 2048
  s_addc_u32 s23, s23, 0
  v_exp_f32 v76, v76
  v_exp_f32 v77, v77
  v_exp_f32 v78, v78
  v_exp_f32 v79, v79
  v_cvt_pk_bf16_f32 v150, v76, v77
  v_cvt_pk_bf16_f32 v151, v78, v79
  v_mfma_f32_32x32x16_bf16 v[120:135], v[56:59], v[156:159], v[120:135]
  v_exp_f32 v80, v80
  v_exp_f32 v81, v81
  v_exp_f32 v82, v82
  v_exp_f32 v83, v83
  v_cvt_pk_bf16_f32 v152, v80, v81
  v_cvt_pk_bf16_f32 v153, v82, v83
  v_mfma_f32_32x32x16_bf16 v[120:135], v[60:63], v[160:163], v[120:135]
  global_load_dwordx4 v[56:59], v3, s[24:25]
  global_load_dwordx4 v[60:63], v3, s[24:25] offset:1024
  s_add_u32 s24, s24, 2048
  s_addc_u32 s25, s25, 0
  v_exp_f32 v84, v84
  v_exp_f32 v85, v85
  v_exp_f32 v86, v86
  v_exp_f32 v87, v87
  v_cvt_pk_bf16_f32 v154, v84, v85
  v_cvt_pk_bf16_f32 v155, v86, v87
  v_exp_f32 v88, v88
  v_exp_f32 v89, v89
  v_exp_f32 v90, v90
  v_exp_f32 v91, v91
  v_cvt_pk_bf16_f32 v156, v88, v89
  v_cvt_pk_bf16_f32 v157, v90, v91
  v_exp_f32 v92, v92
  v_exp_f32 v93, v93
  v_exp_f32 v94, v94
  v_exp_f32 v95, v95
  v_cvt_pk_bf16_f32 v158, v92, v93
  v_cvt_pk_bf16_f32 v159, v94, v95
  s_waitcnt vmcnt(4)
  v_mfma_f32_32x32x16_bf16 v[104:119], v[64:67], v[148:151], v[104:119]
  v_exp_f32 v96, v96
  v_exp_f32 v97, v97
  v_exp_f32 v98, v98
  v_exp_f32 v99, v99
  v_cvt_pk_bf16_f32 v160, v96, v97
  v_cvt_pk_bf16_f32 v161, v98, v99
  v_mfma_f32_32x32x16_bf16 v[104:119], v[68:71], v[152:155], v[104:119]
  v_exp_f32 v100, v100
  v_exp_f32 v101, v101
  v_exp_f32 v102, v102
  v_exp_f32 v103, v103
  v_cvt_pk_bf16_f32 v162, v100, v101
  v_cvt_pk_bf16_f32 v163, v102, v103
  s_nop 1
  v_mfma_f32_32x32x16_bf16 v[120:135], v[64:67], v[156:159], v[120:135]
  v_mfma_f32_32x32x16_bf16 v[120:135], v[68:71], v[160:163], v[120:135]
  global_load_dwordx4 v[64:67], v3, s[24:25]
  global_load_dwordx4 v[68:71], v3, s[24:25] offset:1024
  s_add_u32 s24, s24, 2048
  s_addc_u32 s25, s25, 0
  v_mov_b32 v138, 0xff800000
  v_mov_b32 v139, 0xff800000
  v_mfma_f32_32x32x16_bf16 v[72:87], v[24:27], v[8:11], 0
  v_mfma_f32_32x32x16_bf16 v[72:87], v[28:31], v[12:15], v[72:87]
  v_mfma_f32_32x32x16_bf16 v[88:103], v[24:27], v[16:19], 0
  v_mfma_f32_32x32x16_bf16 v[88:103], v[28:31], v[20:23], v[88:103]
  s_nop 9
  v_max3_f32 v138, v72, v73, v138
  v_max3_f32 v138, v74, v75, v138
  v_max3_f32 v138, v76, v77, v138
  v_max3_f32 v138, v78, v79, v138
  v_max3_f32 v138, v80, v81, v138
  v_max3_f32 v138, v82, v83, v138
  v_max3_f32 v138, v84, v85, v138
  v_max3_f32 v138, v86, v87, v138
  v_mfma_f32_32x32x16_bf16 v[72:87], v[32:35], v[8:11], 0
  v_mfma_f32_32x32x16_bf16 v[72:87], v[36:39], v[12:15], v[72:87]
  s_nop 1
  v_max3_f32 v139, v88, v89, v139
  v_max3_f32 v139, v90, v91, v139
  v_max3_f32 v139, v92, v93, v139
  v_max3_f32 v139, v94, v95, v139
  v_max3_f32 v139, v96, v97, v139
  v_max3_f32 v139, v98, v99, v139
  v_max3_f32 v139, v100, v101, v139
  v_max3_f32 v139, v102, v103, v139
  v_mfma_f32_32x32x16_bf16 v[88:103], v[32:35], v[16:19], 0
  v_mfma_f32_32x32x16_bf16 v[88:103], v[36:39], v[20:23], v[88:103]
  s_nop 1
  v_max3_f32 v138, v72, v73, v138
  v_max3_f32 v138, v74, v75, v138
  v_max3_f32 v138, v76, v77, v138
  v_max3_f32 v138, v78, v79, v138
  v_max3_f32 v138, v80, v81, v138
  v_max3_f32 v138, v82, v83, v138
  v_max3_f32 v138, v84, v85, v138
  v_max3_f32 v138, v86, v87, v138
  v_mfma_f32_32x32x16_bf16 v[72:87], v[40:43], v[8:11], 0
  v_mfma_f32_32x32x16_bf16 v[72:87], v[44:47], v[12:15], v[72:87]
  s_nop 1
  v_max3_f32 v139, v88, v89, v139
  v_max3_f32 v139, v90, v91, v139
  v_max3_f32 v139, v92, v93, v139
  v_max3_f32 v139, v94, v95, v139
  v_max3_f32 v139, v96, v97, v139
  v_max3_f32 v139, v98, v99, v139
  v_max3_f32 v139, v100, v101, v139
  v_max3_f32 v139, v102, v103, v139
  v_mfma_f32_32x32x16_bf16 v[88:103], v[40:43], v[16:19], 0
  v_mfma_f32_32x32x16_bf16 v[88:103], v[44:47], v[20:23], v[88:103]
  s_nop 1
  v_max3_f32 v138, v72, v73, v138
  v_max3_f32 v138, v74, v75, v138
  v_max3_f32 v138, v76, v77, v138
  v_max3_f32 v138, v78, v79, v138
  v_max3_f32 v138, v80, v81, v138
  v_max3_f32 v138, v82, v83, v138
  v_max3_f32 v138, v84, v85, v138
  v_max3_f32 v138, v86, v87, v138
  s_waitcnt vmcnt(4)
  v_mfma_f32_32x32x16_bf16 v[72:87], v[48:51], v[8:11], 0
  v_mfma_f32_32x32x16_bf16 v[72:87], v[52:55], v[12:15], v[72:87]
  s_nop 1
  v_max3_f32 v139, v88, v89, v139
  v_max3_f32 v139, v90, v91, v139
  v_max3_f32 v139, v92, v93, v139
  v_max3_f32 v139, v94, v95, v139
  v_max3_f32 v139, v96, v97, v139
  v_max3_f32 v139, v98, v99, v139
  v_max3_f32 v139, v100, v101, v139
  v_max3_f32 v139, v102, v103, v139
  v_mfma_f32_32x32x16_bf16 v[88:103], v[48:51], v[16:19], 0
  v_mfma_f32_32x32x16_bf16 v[88:103], v[52:55], v[20:23], v[88:103]
  s_nop 1
  v_max3_f32 v138, v72, v73, v138
  v_max3_f32 v138, v74, v75, v138
  v_max3_f32 v138, v76, v77, v138
  v_max3_f32 v138, v78, v79, v138
  v_max3_f32 v138, v80, v81, v138
  v_max3_f32 v138, v82, v83, v138
  v_max3_f32 v138, v84, v85, v138
  v_max3_f32 v138, v86, v87, v138
  s_nop 3
  v_max3_f32 v139, v88, v89, v139
  v_max3_f32 v139, v90, v91, v139
  v_max3_f32 v139, v92, v93, v139
  v_max3_f32 v139, v94, v95, v139
  v_max3_f32 v139, v96, v97, v139
  v_max3_f32 v139, v98, v99, v139
  v_max3_f32 v139, v100, v101, v139
  v_max3_f32 v139, v102, v103, v139
  v_mov_b32 v140, v138
  v_mov_b32 v144, v139
  s_nop 0
  v_permlane32_swap_b32 v138, v140
  v_permlane32_swap_b32 v139, v144
  s_nop 0
  v_max_f32 v138, v138, v140
  v_max_f32 v139, v139, v144
  v_max_f32 v138, 0, v138
  v_max_f32 v139, 0, v139
  v_exp_f32 v141, -v138
  v_exp_f32 v145, -v139
  v_add_f32 v136, v136, v138
  v_add_f32 v137, v137, v139
  v_mul_f32 v104, v141, v104
  v_mul_f32 v120, v145, v120
  v_mul_f32 v105, v141, v105
  v_mul_f32 v121, v145, v121
  v_mul_f32 v106, v141, v106
  v_mul_f32 v122, v145, v122
  v_mul_f32 v107, v141, v107
  v_mul_f32 v123, v145, v123
  v_mul_f32 v108, v141, v108
  v_mul_f32 v124, v145, v124
  v_mul_f32 v109, v141, v109
  v_mul_f32 v125, v145, v125
  v_mul_f32 v110, v141, v110
  v_mul_f32 v126, v145, v126
  v_mul_f32 v111, v141, v111
  v_mul_f32 v127, v145, v127
  v_mul_f32 v112, v141, v112
  v_mul_f32 v128, v145, v128
  v_mul_f32 v113, v141, v113
  v_mul_f32 v129, v145, v129
  v_mul_f32 v114, v141, v114
  v_mul_f32 v130, v145, v130
  v_mul_f32 v115, v141, v115
  v_mul_f32 v131, v145, v131
  v_mul_f32 v116, v141, v116
  v_mul_f32 v132, v145, v132
  v_mul_f32 v117, v141, v117
  v_mul_f32 v133, v145, v133
  v_mul_f32 v118, v141, v118
  v_mul_f32 v134, v145, v134
  v_mul_f32 v119, v141, v119
  v_mul_f32 v135, v145, v135
  v_sub_f32 v140, 0, v136
  v_sub_f32 v144, 0, v137
  v_cvt_pk_bf16_f32 v141, v140, v140
  v_cvt_pk_bf16_f32 v145, v144, v144
  v_lshlrev_b32 v141, 16, v141
  v_lshlrev_b32 v145, 16, v145
  v_sub_f32 v142, v140, v141
  v_sub_f32 v146, v144, v145
  v_cvt_pk_bf16_f32 v141, v142, v142
  v_cvt_pk_bf16_f32 v145, v146, v146
  v_lshlrev_b32 v141, 16, v141
  v_lshlrev_b32 v145, 16, v145
  v_sub_f32 v143, v142, v141
  v_sub_f32 v147, v146, v145
  s_mov_b32 exec_lo, 0
  v_cvt_pk_bf16_f32 v14, v140, v142
  v_cvt_pk_bf16_f32 v15, v143, 0
  v_cvt_pk_bf16_f32 v22, v144, v146
  v_cvt_pk_bf16_f32 v23, v147, 0
  s_mov_b32 exec_lo, -1
  s_nop 3
  v_mfma_f32_32x32x16_bf16 v[72:87], v[24:27], v[8:11], 0
  v_mfma_f32_32x32x16_bf16 v[72:87], v[28:31], v[12:15], v[72:87]
  s_nop 10
  v_mfma_f32_32x32x16_bf16 v[88:103], v[24:27], v[16:19], 0
  v_exp_f32 v72, v72
  v_exp_f32 v73, v73
  v_exp_f32 v74, v74
  v_exp_f32 v75, v75
  v_cvt_pk_bf16_f32 v148, v72, v73
  v_cvt_pk_bf16_f32 v149, v74, v75
  v_mfma_f32_32x32x16_bf16 v[88:103], v[28:31], v[20:23], v[88:103]
  global_load_dwordx4 v[24:27], v3, s[22:23]
  global_load_dwordx4 v[28:31], v3, s[22:23] offset:1024
  s_add_u32 s22, s22, 2048
  s_addc_u32 s23, s23, 0
  v_exp_f32 v76, v76
  v_exp_f32 v77, v77
  v_exp_f32 v78, v78
  v_exp_f32 v79, v79
  v_cvt_pk_bf16_f32 v150, v76, v77
  v_cvt_pk_bf16_f32 v151, v78, v79
  v_exp_f32 v80, v80
  v_exp_f32 v81, v81
  v_exp_f32 v82, v82
  v_exp_f32 v83, v83
  v_cvt_pk_bf16_f32 v152, v80, v81
  v_cvt_pk_bf16_f32 v153, v82, v83
  v_exp_f32 v84, v84
  v_exp_f32 v85, v85
  v_exp_f32 v86, v86
  v_exp_f32 v87, v87
  v_cvt_pk_bf16_f32 v154, v84, v85
  v_cvt_pk_bf16_f32 v155, v86, v87
  v_mfma_f32_32x32x16_bf16 v[72:87], v[32:35], v[8:11], 0
  v_exp_f32 v88, v88
  v_exp_f32 v89, v89
  v_exp_f32 v90, v90
  v_exp_f32 v91, v91
  v_cvt_pk_bf16_f32 v156, v88, v89
  v_cvt_pk_bf16_f32 v157, v90, v91
  v_mfma_f32_32x32x16_bf16 v[72:87], v[36:39], v[12:15], v[72:87]
  v_exp_f32 v92, v92
  v_exp_f32 v93, v93
  v_exp_f32 v94, v94
  v_exp_f32 v95, v95
  v_cvt_pk_bf16_f32 v158, v92, v93
  v_cvt_pk_bf16_f32 v159, v94, v95
  s_waitcnt vmcnt(4)
  v_mfma_f32_32x32x16_bf16 v[104:119], v[56:59], v[148:151], v[104:119]
  v_exp_f32 v96, v96
  v_exp_f32 v97, v97
  v_exp_f32 v98, v98
  v_exp_f32 v99, v99
  v_cvt_pk_bf16_f32 v160, v96, v97
  v_cvt_pk_bf16_f32 v161, v98, v99
  v_mfma_f32_32x32x16_bf16 v[104:119], v[60:63], v[152:155], v[104:119]
  v_exp_f32 v100, v100
  v_exp_f32 v101, v101
  v_exp_f32 v102, v102
  v_exp_f32 v103, v103
  v_cvt_pk_bf16_f32 v162, v100, v101
  v_cvt_pk_bf16_f32 v163, v102, v103
  v_mfma_f32_32x32x16_bf16 v[88:103], v[32:35], v[16:19], 0
  v_exp_f32 v72, v72
  v_exp_f32 v73, v73
  v_exp_f32 v74, v74
  v_exp_f32 v75, v75
  v_cvt_pk_bf16_f32 v148, v72, v73
  v_cvt_pk_bf16_f32 v149, v74, v75
  v_mfma_f32_32x32x16_bf16 v[88:103], v[36:39], v[20:23], v[88:103]
  global_load_dwordx4 v[32:35], v3, s[22:23]
  global_load_dwordx4 v[36:39], v3, s[22:23] offset:1024
  s_add_u32 s22, s22, 2048
  s_addc_u32 s23, s23, 0
  v_exp_f32 v76, v76
  v_exp_f32 v77, v77
  v_exp_f32 v78, v78
  v_exp_f32 v79, v79
  v_cvt_pk_bf16_f32 v150, v76, v77
  v_cvt_pk_bf16_f32 v151, v78, v79
  v_mfma_f32_32x32x16_bf16 v[120:135], v[56:59], v[156:159], v[120:135]
  v_exp_f32 v80, v80
  v_exp_f32 v81, v81
  v_exp_f32 v82, v82
  v_exp_f32 v83, v83
  v_cvt_pk_bf16_f32 v152, v80, v81
  v_cvt_pk_bf16_f32 v153, v82, v83
  v_mfma_f32_32x32x16_bf16 v[120:135], v[60:63], v[160:163], v[120:135]
  global_load_dwordx4 v[56:59], v3, s[24:25]
  global_load_dwordx4 v[60:63], v3, s[24:25] offset:1024
  s_add_u32 s24, s24, 2048
  s_addc_u32 s25, s25, 0
  v_exp_f32 v84, v84
  v_exp_f32 v85, v85
  v_exp_f32 v86, v86
  v_exp_f32 v87, v87
  v_cvt_pk_bf16_f32 v154, v84, v85
  v_cvt_pk_bf16_f32 v155, v86, v87
  v_mfma_f32_32x32x16_bf16 v[72:87], v[40:43], v[8:11], 0
  v_exp_f32 v88, v88
  v_exp_f32 v89, v89
  v_exp_f32 v90, v90
  v_exp_f32 v91, v91
  v_cvt_pk_bf16_f32 v156, v88, v89
  v_cvt_pk_bf16_f32 v157, v90, v91
  v_mfma_f32_32x32x16_bf16 v[72:87], v[44:47], v[12:15], v[72:87]
  v_exp_f32 v92, v92
  v_exp_f32 v93, v93
  v_exp_f32 v94, v94
  v_exp_f32 v95, v95
  v_cvt_pk_bf16_f32 v158, v92, v93
  v_cvt_pk_bf16_f32 v159, v94, v95
  s_waitcnt vmcnt(6)
  v_mfma_f32_32x32x16_bf16 v[104:119], v[64:67], v[148:151], v[104:119]
  v_exp_f32 v96, v96
  v_exp_f32 v97, v97
  v_exp_f32 v98, v98
  v_exp_f32 v99, v99
  v_cvt_pk_bf16_f32 v160, v96, v97
  v_cvt_pk_bf16_f32 v161, v98, v99
  v_mfma_f32_32x32x16_bf16 v[104:119], v[68:71], v[152:155], v[104:119]
  v_exp_f32 v100, v100
  v_exp_f32 v101, v101
  v_exp_f32 v102, v102
  v_exp_f32 v103, v103
  v_cvt_pk_bf16_f32 v162, v100, v101
  v_cvt_pk_bf16_f32 v163, v102, v103
  v_mfma_f32_32x32x16_bf16 v[88:103], v[40:43], v[16:19], 0
  v_exp_f32 v72, v72
  v_exp_f32 v73, v73
  v_exp_f32 v74, v74
  v_exp_f32 v75, v75
  v_cvt_pk_bf16_f32 v148, v72, v73
  v_cvt_pk_bf16_f32 v149, v74, v75
  v_mfma_f32_32x32x16_bf16 v[88:103], v[44:47], v[20:23], v[88:103]
  global_load_dwordx4 v[40:43], v3, s[22:23]
  global_load_dwordx4 v[44:47], v3, s[22:23] offset:1024
  s_add_u32 s22, s22, 2048
  s_addc_u32 s23, s23, 0
  v_exp_f32 v76, v76
  v_exp_f32 v77, v77
  v_exp_f32 v78, v78
  v_exp_f32 v79, v79
  v_cvt_pk_bf16_f32 v150, v76, v77
  v_cvt_pk_bf16_f32 v151, v78, v79
  v_mfma_f32_32x32x16_bf16 v[120:135], v[64:67], v[156:159], v[120:135]
  v_exp_f32 v80, v80
  v_exp_f32 v81, v81
  v_exp_f32 v82, v82
  v_exp_f32 v83, v83
  v_cvt_pk_bf16_f32 v152, v80, v81
  v_cvt_pk_bf16_f32 v153, v82, v83
  v_mfma_f32_32x32x16_bf16 v[120:135], v[68:71], v[160:163], v[120:135]
  global_load_dwordx4 v[64:67], v3, s[24:25]
  global_load_dwordx4 v[68:71], v3, s[24:25] offset:1024
  s_add_u32 s24, s24, 2048
  s_addc_u32 s25, s25, 0
  v_exp_f32 v84, v84
  v_exp_f32 v85, v85
  v_exp_f32 v86, v86
  v_exp_f32 v87, v87
  v_cvt_pk_bf16_f32 v154, v84, v85
  v_cvt_pk_bf16_f32 v155, v86, v87
  v_mfma_f32_32x32x16_bf16 v[72:87], v[48:51], v[8:11], 0
  v_exp_f32 v88, v88
  v_exp_f32 v89, v89
  v_exp_f32 v90, v90
  v_exp_f32 v91, v91
  v_cvt_pk_bf16_f32 v156, v88, v89
  v_cvt_pk_bf16_f32 v157, v90, v91
  v_mfma_f32_32x32x16_bf16 v[72:87], v[52:55], v[12:15], v[72:87]
  v_exp_f32 v92, v92
  v_exp_f32 v93, v93
  v_exp_f32 v94, v94
  v_exp_f32 v95, v95
  v_cvt_pk_bf16_f32 v158, v92, v93
  v_cvt_pk_bf16_f32 v159, v94, v95
  s_waitcnt vmcnt(4)
  v_mfma_f32_32x32x16_bf16 v[104:119], v[56:59], v[148:151], v[104:119]
  v_exp_f32 v96, v96
  v_exp_f32 v97, v97
  v_exp_f32 v98, v98
  v_exp_f32 v99, v99
  v_cvt_pk_bf16_f32 v160, v96, v97
  v_cvt_pk_bf16_f32 v161, v98, v99
  v_mfma_f32_32x32x16_bf16 v[104:119], v[60:63], v[152:155], v[104:119]
  v_exp_f32 v100, v100
  v_exp_f32 v101, v101
  v_exp_f32 v102, v102
  v_exp_f32 v103, v103
  v_cvt_pk_bf16_f32 v162, v100, v101
  v_cvt_pk_bf16_f32 v163, v102, v103
  v_mfma_f32_32x32x16_bf16 v[88:103], v[48:51], v[16:19], 0
  v_exp_f32 v72, v72
  v_exp_f32 v73, v73
  v_exp_f32 v74, v74
  v_exp_f32 v75, v75
  v_cvt_pk_bf16_f32 v148, v72, v73
  v_cvt_pk_bf16_f32 v149, v74, v75
  v_mfma_f32_32x32x16_bf16 v[88:103], v[52:55], v[20:23], v[88:103]
  global_load_dwordx4 v[48:51], v3, s[22:23]
  global_load_dwordx4 v[52:55], v3, s[22:23] offset:1024
  s_add_u32 s22, s22, 2048
  s_addc_u32 s23, s23, 0
  v_exp_f32 v76, v76
  v_exp_f32 v77, v77
  v_exp_f32 v78, v78
  v_exp_f32 v79, v79
  v_cvt_pk_bf16_f32 v150, v76, v77
  v_cvt_pk_bf16_f32 v151, v78, v79
  v_mfma_f32_32x32x16_bf16 v[120:135], v[56:59], v[156:159], v[120:135]
  v_exp_f32 v80, v80
  v_exp_f32 v81, v81
  v_exp_f32 v82, v82
  v_exp_f32 v83, v83
  v_cvt_pk_bf16_f32 v152, v80, v81
  v_cvt_pk_bf16_f32 v153, v82, v83
  v_mfma_f32_32x32x16_bf16 v[120:135], v[60:63], v[160:163], v[120:135]
  global_load_dwordx4 v[56:59], v3, s[24:25]
  global_load_dwordx4 v[60:63], v3, s[24:25] offset:1024
  s_add_u32 s24, s24, 2048
  s_addc_u32 s25, s25, 0
  v_exp_f32 v84, v84
  v_exp_f32 v85, v85
  v_exp_f32 v86, v86
  v_exp_f32 v87, v87
  v_cvt_pk_bf16_f32 v154, v84, v85
  v_cvt_pk_bf16_f32 v155, v86, v87
  v_exp_f32 v88, v88
  v_exp_f32 v89, v89
  v_exp_f32 v90, v90
  v_exp_f32 v91, v91
  v_cvt_pk_bf16_f32 v156, v88, v89
  v_cvt_pk_bf16_f32 v157, v90, v91
  v_exp_f32 v92, v92
  v_exp_f32 v93, v93
  v_exp_f32 v94, v94
  v_exp_f32 v95, v95
  v_cvt_pk_bf16_f32 v158, v92, v93
  v_cvt_pk_bf16_f32 v159, v94, v95
  s_waitcnt vmcnt(4)
  v_mfma_f32_32x32x16_bf16 v[104:119], v[64:67], v[148:151], v[104:119]
  v_exp_f32 v96, v96
  v_exp_f32 v97, v97
  v_exp_f32 v98, v98
  v_exp_f32 v99, v99
  v_cvt_pk_bf16_f32 v160, v96, v97
  v_cvt_pk_bf16_f32 v161, v98, v99
  v_mfma_f32_32x32x16_bf16 v[104:119], v[68:71], v[152:155], v[104:119]
  v_exp_f32 v100, v100
  v_exp_f32 v101, v101
  v_exp_f32 v102, v102
  v_exp_f32 v103, v103
  v_cvt_pk_bf16_f32 v162, v100, v101
  v_cvt_pk_bf16_f32 v163, v102, v103
  s_nop 1
  v_mfma_f32_32x32x16_bf16 v[120:135], v[64:67], v[156:159], v[120:135]
  v_mfma_f32_32x32x16_bf16 v[120:135], v[68:71], v[160:163], v[120:135]
  global_load_dwordx4 v[64:67], v3, s[24:25]
  global_load_dwordx4 v[68:71], v3, s[24:25] offset:1024
  s_add_u32 s24, s24, 2048
  s_addc_u32 s25, s25, 0
  v_mov_b32 v138, 0xff800000
  v_mov_b32 v139, 0xff800000
  v_mfma_f32_32x32x16_bf16 v[72:87], v[24:27], v[8:11], 0
  v_mfma_f32_32x32x16_bf16 v[72:87], v[28:31], v[12:15], v[72:87]
  v_mfma_f32_32x32x16_bf16 v[88:103], v[24:27], v[16:19], 0
  v_mfma_f32_32x32x16_bf16 v[88:103], v[28:31], v[20:23], v[88:103]
  s_nop 9
  v_max3_f32 v138, v72, v73, v138
  v_max3_f32 v138, v74, v75, v138
  v_max3_f32 v138, v76, v77, v138
  v_max3_f32 v138, v78, v79, v138
  v_max3_f32 v138, v80, v81, v138
  v_max3_f32 v138, v82, v83, v138
  v_max3_f32 v138, v84, v85, v138
  v_max3_f32 v138, v86, v87, v138
  v_mfma_f32_32x32x16_bf16 v[72:87], v[32:35], v[8:11], 0
  v_mfma_f32_32x32x16_bf16 v[72:87], v[36:39], v[12:15], v[72:87]
  s_nop 1
  v_max3_f32 v139, v88, v89, v139
  v_max3_f32 v139, v90, v91, v139
  v_max3_f32 v139, v92, v93, v139
  v_max3_f32 v139, v94, v95, v139
  v_max3_f32 v139, v96, v97, v139
  v_max3_f32 v139, v98, v99, v139
  v_max3_f32 v139, v100, v101, v139
  v_max3_f32 v139, v102, v103, v139
  v_mfma_f32_32x32x16_bf16 v[88:103], v[32:35], v[16:19], 0
  v_mfma_f32_32x32x16_bf16 v[88:103], v[36:39], v[20:23], v[88:103]
  s_nop 1
  v_max3_f32 v138, v72, v73, v138
  v_max3_f32 v138, v74, v75, v138
  v_max3_f32 v138, v76, v77, v138
  v_max3_f32 v138, v78, v79, v138
  v_max3_f32 v138, v80, v81, v138
  v_max3_f32 v138, v82, v83, v138
  v_max3_f32 v138, v84, v85, v138
  v_max3_f32 v138, v86, v87, v138
  v_mfma_f32_32x32x16_bf16 v[72:87], v[40:43], v[8:11], 0
  v_mfma_f32_32x32x16_bf16 v[72:87], v[44:47], v[12:15], v[72:87]
  s_nop 1
  v_max3_f32 v139, v88, v89, v139
  v_max3_f32 v139, v90, v91, v139
  v_max3_f32 v139, v92, v93, v139
  v_max3_f32 v139, v94, v95, v139
  v_max3_f32 v139, v96, v97, v139
  v_max3_f32 v139, v98, v99, v139
  v_max3_f32 v139, v100, v101, v139
  v_max3_f32 v139, v102, v103, v139
  v_mfma_f32_32x32x16_bf16 v[88:103], v[40:43], v[16:19], 0
  v_mfma_f32_32x32x16_bf16 v[88:103], v[44:47], v[20:23], v[88:103]
  s_nop 1
  v_max3_f32 v138, v72, v73, v138
  v_max3_f32 v138, v74, v75, v138
  v_max3_f32 v138, v76, v77, v138
  v_max3_f32 v138, v78, v79, v138
  v_max3_f32 v138, v80, v81, v138
  v_max3_f32 v138, v82, v83, v138
  v_max3_f32 v138, v84, v85, v138
  v_max3_f32 v138, v86, v87, v138
  s_waitcnt vmcnt(4)
  v_mfma_f32_32x32x16_bf16 v[72:87], v[48:51], v[8:11], 0
  v_mfma_f32_32x32x16_bf16 v[72:87], v[52:55], v[12:15], v[72:87]
  s_nop 1
  v_max3_f32 v139, v88, v89, v139
  v_max3_f32 v139, v90, v91, v139
  v_max3_f32 v139, v92, v93, v139
  v_max3_f32 v139, v94, v95, v139
  v_max3_f32 v139, v96, v97, v139
  v_max3_f32 v139, v98, v99, v139
  v_max3_f32 v139, v100, v101, v139
  v_max3_f32 v139, v102, v103, v139
  v_mfma_f32_32x32x16_bf16 v[88:103], v[48:51], v[16:19], 0
  v_mfma_f32_32x32x16_bf16 v[88:103], v[52:55], v[20:23], v[88:103]
  s_nop 1
  v_max3_f32 v138, v72, v73, v138
  v_max3_f32 v138, v74, v75, v138
  v_max3_f32 v138, v76, v77, v138
  v_max3_f32 v138, v78, v79, v138
  v_max3_f32 v138, v80, v81, v138
  v_max3_f32 v138, v82, v83, v138
  v_max3_f32 v138, v84, v85, v138
  v_max3_f32 v138, v86, v87, v138
  s_nop 3
  v_max3_f32 v139, v88, v89, v139
  v_max3_f32 v139, v90, v91, v139
  v_max3_f32 v139, v92, v93, v139
  v_max3_f32 v139, v94, v95, v139
  v_max3_f32 v139, v96, v97, v139
  v_max3_f32 v139, v98, v99, v139
  v_max3_f32 v139, v100, v101, v139
  v_max3_f32 v139, v102, v103, v139
  v_mov_b32 v140, v138
  v_mov_b32 v144, v139
  s_nop 0
  v_permlane32_swap_b32 v138, v140
  v_permlane32_swap_b32 v139, v144
  s_nop 0
  v_max_f32 v138, v138, v140
  v_max_f32 v139, v139, v144
  v_max_f32 v138, 0, v138
  v_max_f32 v139, 0, v139
  v_exp_f32 v141, -v138
  v_exp_f32 v145, -v139
  v_add_f32 v136, v136, v138
  v_add_f32 v137, v137, v139
  v_mul_f32 v104, v141, v104
  v_mul_f32 v120, v145, v120
  v_mul_f32 v105, v141, v105
  v_mul_f32 v121, v145, v121
  v_mul_f32 v106, v141, v106
  v_mul_f32 v122, v145, v122
  v_mul_f32 v107, v141, v107
  v_mul_f32 v123, v145, v123
  v_mul_f32 v108, v141, v108
  v_mul_f32 v124, v145, v124
  v_mul_f32 v109, v141, v109
  v_mul_f32 v125, v145, v125
  v_mul_f32 v110, v141, v110
  v_mul_f32 v126, v145, v126
  v_mul_f32 v111, v141, v111
  v_mul_f32 v127, v145, v127
  v_mul_f32 v112, v141, v112
  v_mul_f32 v128, v145, v128
  v_mul_f32 v113, v141, v113
  v_mul_f32 v129, v145, v129
  v_mul_f32 v114, v141, v114
  v_mul_f32 v130, v145, v130
  v_mul_f32 v115, v141, v115
  v_mul_f32 v131, v145, v131
  v_mul_f32 v116, v141, v116
  v_mul_f32 v132, v145, v132
  v_mul_f32 v117, v141, v117
  v_mul_f32 v133, v145, v133
  v_mul_f32 v118, v141, v118
  v_mul_f32 v134, v145, v134
  v_mul_f32 v119, v141, v119
  v_mul_f32 v135, v145, v135
  v_sub_f32 v140, 0, v136
  v_sub_f32 v144, 0, v137
  v_cvt_pk_bf16_f32 v141, v140, v140
  v_cvt_pk_bf16_f32 v145, v144, v144
  v_lshlrev_b32 v141, 16, v141
  v_lshlrev_b32 v145, 16, v145
  v_sub_f32 v142, v140, v141
  v_sub_f32 v146, v144, v145
  v_cvt_pk_bf16_f32 v141, v142, v142
  v_cvt_pk_bf16_f32 v145, v146, v146
  v_lshlrev_b32 v141, 16, v141
  v_lshlrev_b32 v145, 16, v145
  v_sub_f32 v143, v142, v141
  v_sub_f32 v147, v146, v145
  s_mov_b32 exec_lo, 0
  v_cvt_pk_bf16_f32 v14, v140, v142
  v_cvt_pk_bf16_f32 v15, v143, 0
  v_cvt_pk_bf16_f32 v22, v144, v146
  v_cvt_pk_bf16_f32 v23, v147, 0
  s_mov_b32 exec_lo, -1
  s_nop 3
  v_mfma_f32_32x32x16_bf16 v[72:87], v[24:27], v[8:11], 0
  v_mfma_f32_32x32x16_bf16 v[72:87], v[28:31], v[12:15], v[72:87]
  s_nop 10
  v_mfma_f32_32x32x16_bf16 v[88:103], v[24:27], v[16:19], 0
  v_exp_f32 v72, v72
  v_exp_f32 v73, v73
  v_exp_f32 v74, v74
  v_exp_f32 v75, v75
  v_cvt_pk_bf16_f32 v148, v72, v73
  v_cvt_pk_bf16_f32 v149, v74, v75
  v_mfma_f32_32x32x16_bf16 v[88:103], v[28:31], v[20:23], v[88:103]
  global_load_dwordx4 v[24:27], v3, s[22:23]
  global_load_dwordx4 v[28:31], v3, s[22:23] offset:1024
  s_add_u32 s22, s22, 2048
  s_addc_u32 s23, s23, 0
  v_exp_f32 v76, v76
  v_exp_f32 v77, v77
  v_exp_f32 v78, v78
  v_exp_f32 v79, v79
  v_cvt_pk_bf16_f32 v150, v76, v77
  v_cvt_pk_bf16_f32 v151, v78, v79
  v_exp_f32 v80, v80
  v_exp_f32 v81, v81
  v_exp_f32 v82, v82
  v_exp_f32 v83, v83
  v_cvt_pk_bf16_f32 v152, v80, v81
  v_cvt_pk_bf16_f32 v153, v82, v83
  v_exp_f32 v84, v84
  v_exp_f32 v85, v85
  v_exp_f32 v86, v86
  v_exp_f32 v87, v87
  v_cvt_pk_bf16_f32 v154, v84, v85
  v_cvt_pk_bf16_f32 v155, v86, v87
  v_mfma_f32_32x32x16_bf16 v[72:87], v[32:35], v[8:11], 0
  v_exp_f32 v88, v88
  v_exp_f32 v89, v89
  v_exp_f32 v90, v90
  v_exp_f32 v91, v91
  v_cvt_pk_bf16_f32 v156, v88, v89
  v_cvt_pk_bf16_f32 v157, v90, v91
  v_mfma_f32_32x32x16_bf16 v[72:87], v[36:39], v[12:15], v[72:87]
  v_exp_f32 v92, v92
  v_exp_f32 v93, v93
  v_exp_f32 v94, v94
  v_exp_f32 v95, v95
  v_cvt_pk_bf16_f32 v158, v92, v93
  v_cvt_pk_bf16_f32 v159, v94, v95
  s_waitcnt vmcnt(4)
  v_mfma_f32_32x32x16_bf16 v[104:119], v[56:59], v[148:151], v[104:119]
  v_exp_f32 v96, v96
  v_exp_f32 v97, v97
  v_exp_f32 v98, v98
  v_exp_f32 v99, v99
  v_cvt_pk_bf16_f32 v160, v96, v97
  v_cvt_pk_bf16_f32 v161, v98, v99
  v_mfma_f32_32x32x16_bf16 v[104:119], v[60:63], v[152:155], v[104:119]
  v_exp_f32 v100, v100
  v_exp_f32 v101, v101
  v_exp_f32 v102, v102
  v_exp_f32 v103, v103
  v_cvt_pk_bf16_f32 v162, v100, v101
  v_cvt_pk_bf16_f32 v163, v102, v103
  v_mfma_f32_32x32x16_bf16 v[88:103], v[32:35], v[16:19], 0
  v_exp_f32 v72, v72
  v_exp_f32 v73, v73
  v_exp_f32 v74, v74
  v_exp_f32 v75, v75
  v_cvt_pk_bf16_f32 v148, v72, v73
  v_cvt_pk_bf16_f32 v149, v74, v75
  v_mfma_f32_32x32x16_bf16 v[88:103], v[36:39], v[20:23], v[88:103]
  global_load_dwordx4 v[32:35], v3, s[22:23]
  global_load_dwordx4 v[36:39], v3, s[22:23] offset:1024
  s_add_u32 s22, s22, 2048
  s_addc_u32 s23, s23, 0
  v_exp_f32 v76, v76
  v_exp_f32 v77, v77
  v_exp_f32 v78, v78
  v_exp_f32 v79, v79
  v_cvt_pk_bf16_f32 v150, v76, v77
  v_cvt_pk_bf16_f32 v151, v78, v79
  v_mfma_f32_32x32x16_bf16 v[120:135], v[56:59], v[156:159], v[120:135]
  v_exp_f32 v80, v80
  v_exp_f32 v81, v81
  v_exp_f32 v82, v82
  v_exp_f32 v83, v83
  v_cvt_pk_bf16_f32 v152, v80, v81
  v_cvt_pk_bf16_f32 v153, v82, v83
  v_mfma_f32_32x32x16_bf16 v[120:135], v[60:63], v[160:163], v[120:135]
  global_load_dwordx4 v[56:59], v3, s[24:25]
  global_load_dwordx4 v[60:63], v3, s[24:25] offset:1024
  s_add_u32 s24, s24, 2048
  s_addc_u32 s25, s25, 0
  v_exp_f32 v84, v84
  v_exp_f32 v85, v85
  v_exp_f32 v86, v86
  v_exp_f32 v87, v87
  v_cvt_pk_bf16_f32 v154, v84, v85
  v_cvt_pk_bf16_f32 v155, v86, v87
  v_mfma_f32_32x32x16_bf16 v[72:87], v[40:43], v[8:11], 0
  v_exp_f32 v88, v88
  v_exp_f32 v89, v89
  v_exp_f32 v90, v90
  v_exp_f32 v91, v91
  v_cvt_pk_bf16_f32 v156, v88, v89
  v_cvt_pk_bf16_f32 v157, v90, v91
  v_mfma_f32_32x32x16_bf16 v[72:87], v[44:47], v[12:15], v[72:87]
  v_exp_f32 v92, v92
  v_exp_f32 v93, v93
  v_exp_f32 v94, v94
  v_exp_f32 v95, v95
  v_cvt_pk_bf16_f32 v158, v92, v93
  v_cvt_pk_bf16_f32 v159, v94, v95
  s_waitcnt vmcnt(6)
  v_mfma_f32_32x32x16_bf16 v[104:119], v[64:67], v[148:151], v[104:119]
  v_exp_f32 v96, v96
  v_exp_f32 v97, v97
  v_exp_f32 v98, v98
  v_exp_f32 v99, v99
  v_cvt_pk_bf16_f32 v160, v96, v97
  v_cvt_pk_bf16_f32 v161, v98, v99
  v_mfma_f32_32x32x16_bf16 v[104:119], v[68:71], v[152:155], v[104:119]
  v_exp_f32 v100, v100
  v_exp_f32 v101, v101
  v_exp_f32 v102, v102
  v_exp_f32 v103, v103
  v_cvt_pk_bf16_f32 v162, v100, v101
  v_cvt_pk_bf16_f32 v163, v102, v103
  v_mfma_f32_32x32x16_bf16 v[88:103], v[40:43], v[16:19], 0
  v_exp_f32 v72, v72
  v_exp_f32 v73, v73
  v_exp_f32 v74, v74
  v_exp_f32 v75, v75
  v_cvt_pk_bf16_f32 v148, v72, v73
  v_cvt_pk_bf16_f32 v149, v74, v75
  v_mfma_f32_32x32x16_bf16 v[88:103], v[44:47], v[20:23], v[88:103]
  global_load_dwordx4 v[40:43], v3, s[22:23]
  global_load_dwordx4 v[44:47], v3, s[22:23] offset:1024
  s_add_u32 s22, s22, 2048
  s_addc_u32 s23, s23, 0
  v_exp_f32 v76, v76
  v_exp_f32 v77, v77
  v_exp_f32 v78, v78
  v_exp_f32 v79, v79
  v_cvt_pk_bf16_f32 v150, v76, v77
  v_cvt_pk_bf16_f32 v151, v78, v79
  v_mfma_f32_32x32x16_bf16 v[120:135], v[64:67], v[156:159], v[120:135]
  v_exp_f32 v80, v80
  v_exp_f32 v81, v81
  v_exp_f32 v82, v82
  v_exp_f32 v83, v83
  v_cvt_pk_bf16_f32 v152, v80, v81
  v_cvt_pk_bf16_f32 v153, v82, v83
  v_mfma_f32_32x32x16_bf16 v[120:135], v[68:71], v[160:163], v[120:135]
  global_load_dwordx4 v[64:67], v3, s[24:25]
  global_load_dwordx4 v[68:71], v3, s[24:25] offset:1024
  s_add_u32 s24, s24, 2048
  s_addc_u32 s25, s25, 0
  v_exp_f32 v84, v84
  v_exp_f32 v85, v85
  v_exp_f32 v86, v86
  v_exp_f32 v87, v87
  v_cvt_pk_bf16_f32 v154, v84, v85
  v_cvt_pk_bf16_f32 v155, v86, v87
  v_mfma_f32_32x32x16_bf16 v[72:87], v[48:51], v[8:11], 0
  v_exp_f32 v88, v88
  v_exp_f32 v89, v89
  v_exp_f32 v90, v90
  v_exp_f32 v91, v91
  v_cvt_pk_bf16_f32 v156, v88, v89
  v_cvt_pk_bf16_f32 v157, v90, v91
  v_mfma_f32_32x32x16_bf16 v[72:87], v[52:55], v[12:15], v[72:87]
  v_exp_f32 v92, v92
  v_exp_f32 v93, v93
  v_exp_f32 v94, v94
  v_exp_f32 v95, v95
  v_cvt_pk_bf16_f32 v158, v92, v93
  v_cvt_pk_bf16_f32 v159, v94, v95
  s_waitcnt vmcnt(4)
  v_mfma_f32_32x32x16_bf16 v[104:119], v[56:59], v[148:151], v[104:119]
  v_exp_f32 v96, v96
  v_exp_f32 v97, v97
  v_exp_f32 v98, v98
  v_exp_f32 v99, v99
  v_cvt_pk_bf16_f32 v160, v96, v97
  v_cvt_pk_bf16_f32 v161, v98, v99
  v_mfma_f32_32x32x16_bf16 v[104:119], v[60:63], v[152:155], v[104:119]
  v_exp_f32 v100, v100
  v_exp_f32 v101, v101
  v_exp_f32 v102, v102
  v_exp_f32 v103, v103
  v_cvt_pk_bf16_f32 v162, v100, v101
  v_cvt_pk_bf16_f32 v163, v102, v103
  v_mfma_f32_32x32x16_bf16 v[88:103], v[48:51], v[16:19], 0
  v_exp_f32 v72, v72
  v_exp_f32 v73, v73
  v_exp_f32 v74, v74
  v_exp_f32 v75, v75
  v_cvt_pk_bf16_f32 v148, v72, v73
  v_cvt_pk_bf16_f32 v149, v74, v75
  v_mfma_f32_32x32x16_bf16 v[88:103], v[52:55], v[20:23], v[88:103]
  global_load_dwordx4 v[48:51], v3, s[22:23]
  global_load_dwordx4 v[52:55], v3, s[22:23] offset:1024
  s_add_u32 s22, s22, 2048
  s_addc_u32 s23, s23, 0
  v_exp_f32 v76, v76
  v_exp_f32 v77, v77
  v_exp_f32 v78, v78
  v_exp_f32 v79, v79
  v_cvt_pk_bf16_f32 v150, v76, v77
  v_cvt_pk_bf16_f32 v151, v78, v79
  v_mfma_f32_32x32x16_bf16 v[120:135], v[56:59], v[156:159], v[120:135]
  v_exp_f32 v80, v80
  v_exp_f32 v81, v81
  v_exp_f32 v82, v82
  v_exp_f32 v83, v83
  v_cvt_pk_bf16_f32 v152, v80, v81
  v_cvt_pk_bf16_f32 v153, v82, v83
  v_mfma_f32_32x32x16_bf16 v[120:135], v[60:63], v[160:163], v[120:135]
  global_load_dwordx4 v[56:59], v3, s[24:25]
  global_load_dwordx4 v[60:63], v3, s[24:25] offset:1024
  s_add_u32 s24, s24, 2048
  s_addc_u32 s25, s25, 0
  v_exp_f32 v84, v84
  v_exp_f32 v85, v85
  v_exp_f32 v86, v86
  v_exp_f32 v87, v87
  v_cvt_pk_bf16_f32 v154, v84, v85
  v_cvt_pk_bf16_f32 v155, v86, v87
  v_exp_f32 v88, v88
  v_exp_f32 v89, v89
  v_exp_f32 v90, v90
  v_exp_f32 v91, v91
  v_cvt_pk_bf16_f32 v156, v88, v89
  v_cvt_pk_bf16_f32 v157, v90, v91
  v_exp_f32 v92, v92
  v_exp_f32 v93, v93
  v_exp_f32 v94, v94
  v_exp_f32 v95, v95
  v_cvt_pk_bf16_f32 v158, v92, v93
  v_cvt_pk_bf16_f32 v159, v94, v95
  s_waitcnt vmcnt(4)
  v_mfma_f32_32x32x16_bf16 v[104:119], v[64:67], v[148:151], v[104:119]
  v_exp_f32 v96, v96
  v_exp_f32 v97, v97
  v_exp_f32 v98, v98
  v_exp_f32 v99, v99
  v_cvt_pk_bf16_f32 v160, v96, v97
  v_cvt_pk_bf16_f32 v161, v98, v99
  v_mfma_f32_32x32x16_bf16 v[104:119], v[68:71], v[152:155], v[104:119]
  v_exp_f32 v100, v100
  v_exp_f32 v101, v101
  v_exp_f32 v102, v102
  v_exp_f32 v103, v103
  v_cvt_pk_bf16_f32 v162, v100, v101
  v_cvt_pk_bf16_f32 v163, v102, v103
  s_nop 1
  v_mfma_f32_32x32x16_bf16 v[120:135], v[64:67], v[156:159], v[120:135]
  v_mfma_f32_32x32x16_bf16 v[120:135], v[68:71], v[160:163], v[120:135]
  global_load_dwordx4 v[64:67], v3, s[24:25]
  global_load_dwordx4 v[68:71], v3, s[24:25] offset:1024
  s_add_u32 s24, s24, 2048
  s_addc_u32 s25, s25, 0
  v_mov_b32 v138, 0xff800000
  v_mov_b32 v139, 0xff800000
  v_mfma_f32_32x32x16_bf16 v[72:87], v[24:27], v[8:11], 0
  v_mfma_f32_32x32x16_bf16 v[72:87], v[28:31], v[12:15], v[72:87]
  v_mfma_f32_32x32x16_bf16 v[88:103], v[24:27], v[16:19], 0
  v_mfma_f32_32x32x16_bf16 v[88:103], v[28:31], v[20:23], v[88:103]
  s_nop 9
  v_max3_f32 v138, v72, v73, v138
  v_max3_f32 v138, v74, v75, v138
  v_max3_f32 v138, v76, v77, v138
  v_max3_f32 v138, v78, v79, v138
  v_max3_f32 v138, v80, v81, v138
  v_max3_f32 v138, v82, v83, v138
  v_max3_f32 v138, v84, v85, v138
  v_max3_f32 v138, v86, v87, v138
  v_mfma_f32_32x32x16_bf16 v[72:87], v[32:35], v[8:11], 0
  v_mfma_f32_32x32x16_bf16 v[72:87], v[36:39], v[12:15], v[72:87]
  s_nop 1
  v_max3_f32 v139, v88, v89, v139
  v_max3_f32 v139, v90, v91, v139
  v_max3_f32 v139, v92, v93, v139
  v_max3_f32 v139, v94, v95, v139
  v_max3_f32 v139, v96, v97, v139
  v_max3_f32 v139, v98, v99, v139
  v_max3_f32 v139, v100, v101, v139
  v_max3_f32 v139, v102, v103, v139
  v_mfma_f32_32x32x16_bf16 v[88:103], v[32:35], v[16:19], 0
  v_mfma_f32_32x32x16_bf16 v[88:103], v[36:39], v[20:23], v[88:103]
  s_nop 1
  v_max3_f32 v138, v72, v73, v138
  v_max3_f32 v138, v74, v75, v138
  v_max3_f32 v138, v76, v77, v138
  v_max3_f32 v138, v78, v79, v138
  v_max3_f32 v138, v80, v81, v138
  v_max3_f32 v138, v82, v83, v138
  v_max3_f32 v138, v84, v85, v138
  v_max3_f32 v138, v86, v87, v138
  v_mfma_f32_32x32x16_bf16 v[72:87], v[40:43], v[8:11], 0
  v_mfma_f32_32x32x16_bf16 v[72:87], v[44:47], v[12:15], v[72:87]
  s_nop 1
  v_max3_f32 v139, v88, v89, v139
  v_max3_f32 v139, v90, v91, v139
  v_max3_f32 v139, v92, v93, v139
  v_max3_f32 v139, v94, v95, v139
  v_max3_f32 v139, v96, v97, v139
  v_max3_f32 v139, v98, v99, v139
  v_max3_f32 v139, v100, v101, v139
  v_max3_f32 v139, v102, v103, v139
  v_mfma_f32_32x32x16_bf16 v[88:103], v[40:43], v[16:19], 0
  v_mfma_f32_32x32x16_bf16 v[88:103], v[44:47], v[20:23], v[88:103]
  s_nop 1
  v_max3_f32 v138, v72, v73, v138
  v_max3_f32 v138, v74, v75, v138
  v_max3_f32 v138, v76, v77, v138
  v_max3_f32 v138, v78, v79, v138
  v_max3_f32 v138, v80, v81, v138
  v_max3_f32 v138, v82, v83, v138
  v_max3_f32 v138, v84, v85, v138
  v_max3_f32 v138, v86, v87, v138
  s_waitcnt vmcnt(4)
  v_mfma_f32_32x32x16_bf16 v[72:87], v[48:51], v[8:11], 0
  v_mfma_f32_32x32x16_bf16 v[72:87], v[52:55], v[12:15], v[72:87]
  s_nop 1
  v_max3_f32 v139, v88, v89, v139
  v_max3_f32 v139, v90, v91, v139
  v_max3_f32 v139, v92, v93, v139
  v_max3_f32 v139, v94, v95, v139
  v_max3_f32 v139, v96, v97, v139
  v_max3_f32 v139, v98, v99, v139
  v_max3_f32 v139, v100, v101, v139
  v_max3_f32 v139, v102, v103, v139
  v_mfma_f32_32x32x16_bf16 v[88:103], v[48:51], v[16:19], 0
  v_mfma_f32_32x32x16_bf16 v[88:103], v[52:55], v[20:23], v[88:103]
  s_nop 1
  v_max3_f32 v138, v72, v73, v138
  v_max3_f32 v138, v74, v75, v138
  v_max3_f32 v138, v76, v77, v138
  v_max3_f32 v138, v78, v79, v138
  v_max3_f32 v138, v80, v81, v138
  v_max3_f32 v138, v82, v83, v138
  v_max3_f32 v138, v84, v85, v138
  v_max3_f32 v138, v86, v87, v138
  s_nop 3
  v_max3_f32 v139, v88, v89, v139
  v_max3_f32 v139, v90, v91, v139
  v_max3_f32 v139, v92, v93, v139
  v_max3_f32 v139, v94, v95, v139
  v_max3_f32 v139, v96, v97, v139
  v_max3_f32 v139, v98, v99, v139
  v_max3_f32 v139, v100, v101, v139
  v_max3_f32 v139, v102, v103, v139
  v_mov_b32 v140, v138
  v_mov_b32 v144, v139
  s_nop 0
  v_permlane32_swap_b32 v138, v140
  v_permlane32_swap_b32 v139, v144
  s_nop 0
  v_max_f32 v138, v138, v140
  v_max_f32 v139, v139, v144
  v_max_f32 v138, 0, v138
  v_max_f32 v139, 0, v139
  v_exp_f32 v141, -v138
  v_exp_f32 v145, -v139
  v_add_f32 v136, v136, v138
  v_add_f32 v137, v137, v139
  v_mul_f32 v104, v141, v104
  v_mul_f32 v120, v145, v120
  v_mul_f32 v105, v141, v105
  v_mul_f32 v121, v145, v121
  v_mul_f32 v106, v141, v106
  v_mul_f32 v122, v145, v122
  v_mul_f32 v107, v141, v107
  v_mul_f32 v123, v145, v123
  v_mul_f32 v108, v141, v108
  v_mul_f32 v124, v145, v124
  v_mul_f32 v109, v141, v109
  v_mul_f32 v125, v145, v125
  v_mul_f32 v110, v141, v110
  v_mul_f32 v126, v145, v126
  v_mul_f32 v111, v141, v111
  v_mul_f32 v127, v145, v127
  v_mul_f32 v112, v141, v112
  v_mul_f32 v128, v145, v128
  v_mul_f32 v113, v141, v113
  v_mul_f32 v129, v145, v129
  v_mul_f32 v114, v141, v114
  v_mul_f32 v130, v145, v130
  v_mul_f32 v115, v141, v115
  v_mul_f32 v131, v145, v131
  v_mul_f32 v116, v141, v116
  v_mul_f32 v132, v145, v132
  v_mul_f32 v117, v141, v117
  v_mul_f32 v133, v145, v133
  v_mul_f32 v118, v141, v118
  v_mul_f32 v134, v145, v134
  v_mul_f32 v119, v141, v119
  v_mul_f32 v135, v145, v135
  v_sub_f32 v140, 0, v136
  v_sub_f32 v144, 0, v137
  v_cvt_pk_bf16_f32 v141, v140, v140
  v_cvt_pk_bf16_f32 v145, v144, v144
  v_lshlrev_b32 v141, 16, v141
  v_lshlrev_b32 v145, 16, v145
  v_sub_f32 v142, v140, v141
  v_sub_f32 v146, v144, v145
  v_cvt_pk_bf16_f32 v141, v142, v142
  v_cvt_pk_bf16_f32 v145, v146, v146
  v_lshlrev_b32 v141, 16, v141
  v_lshlrev_b32 v145, 16, v145
  v_sub_f32 v143, v142, v141
  v_sub_f32 v147, v146, v145
  s_mov_b32 exec_lo, 0
  v_cvt_pk_bf16_f32 v14, v140, v142
  v_cvt_pk_bf16_f32 v15, v143, 0
  v_cvt_pk_bf16_f32 v22, v144, v146
  v_cvt_pk_bf16_f32 v23, v147, 0
  s_mov_b32 exec_lo, -1
  s_nop 3
  v_mfma_f32_32x32x16_bf16 v[72:87], v[24:27], v[8:11], 0
  v_mfma_f32_32x32x16_bf16 v[72:87], v[28:31], v[12:15], v[72:87]
  s_nop 10
  v_mfma_f32_32x32x16_bf16 v[88:103], v[24:27], v[16:19], 0
  v_exp_f32 v72, v72
  v_exp_f32 v73, v73
  v_exp_f32 v74, v74
  v_exp_f32 v75, v75
  v_cvt_pk_bf16_f32 v148, v72, v73
  v_cvt_pk_bf16_f32 v149, v74, v75
  v_mfma_f32_32x32x16_bf16 v[88:103], v[28:31], v[20:23], v[88:103]
  v_exp_f32 v76, v76
  v_exp_f32 v77, v77
  v_exp_f32 v78, v78
  v_exp_f32 v79, v79
  v_cvt_pk_bf16_f32 v150, v76, v77
  v_cvt_pk_bf16_f32 v151, v78, v79
  v_exp_f32 v80, v80
  v_exp_f32 v81, v81
  v_exp_f32 v82, v82
  v_exp_f32 v83, v83
  v_cvt_pk_bf16_f32 v152, v80, v81
  v_cvt_pk_bf16_f32 v153, v82, v83
  v_exp_f32 v84, v84
  v_exp_f32 v85, v85
  v_exp_f32 v86, v86
  v_exp_f32 v87, v87
  v_cvt_pk_bf16_f32 v154, v84, v85
  v_cvt_pk_bf16_f32 v155, v86, v87
  v_mfma_f32_32x32x16_bf16 v[72:87], v[32:35], v[8:11], 0
  v_exp_f32 v88, v88
  v_exp_f32 v89, v89
  v_exp_f32 v90, v90
  v_exp_f32 v91, v91
  v_cvt_pk_bf16_f32 v156, v88, v89
  v_cvt_pk_bf16_f32 v157, v90, v91
  v_mfma_f32_32x32x16_bf16 v[72:87], v[36:39], v[12:15], v[72:87]
  v_exp_f32 v92, v92
  v_exp_f32 v93, v93
  v_exp_f32 v94, v94
  v_exp_f32 v95, v95
  v_cvt_pk_bf16_f32 v158, v92, v93
  v_cvt_pk_bf16_f32 v159, v94, v95
  s_waitcnt vmcnt(2)
  v_mfma_f32_32x32x16_bf16 v[104:119], v[56:59], v[148:151], v[104:119]
  v_exp_f32 v96, v96
  v_exp_f32 v97, v97
  v_exp_f32 v98, v98
  v_exp_f32 v99, v99
  v_cvt_pk_bf16_f32 v160, v96, v97
  v_cvt_pk_bf16_f32 v161, v98, v99
  v_mfma_f32_32x32x16_bf16 v[104:119], v[60:63], v[152:155], v[104:119]
  v_exp_f32 v100, v100
  v_exp_f32 v101, v101
  v_exp_f32 v102, v102
  v_exp_f32 v103, v103
  v_cvt_pk_bf16_f32 v162, v100, v101
  v_cvt_pk_bf16_f32 v163, v102, v103
  v_mfma_f32_32x32x16_bf16 v[88:103], v[32:35], v[16:19], 0
  v_exp_f32 v72, v72
  v_exp_f32 v73, v73
  v_exp_f32 v74, v74
  v_exp_f32 v75, v75
  v_cvt_pk_bf16_f32 v148, v72, v73
  v_cvt_pk_bf16_f32 v149, v74, v75
  v_mfma_f32_32x32x16_bf16 v[88:103], v[36:39], v[20:23], v[88:103]
  v_exp_f32 v76, v76
  v_exp_f32 v77, v77
  v_exp_f32 v78, v78
  v_exp_f32 v79, v79
  v_cvt_pk_bf16_f32 v150, v76, v77
  v_cvt_pk_bf16_f32 v151, v78, v79
  v_mfma_f32_32x32x16_bf16 v[120:135], v[56:59], v[156:159], v[120:135]
  v_exp_f32 v80, v80
  v_exp_f32 v81, v81
  v_exp_f32 v82, v82
  v_exp_f32 v83, v83
  v_cvt_pk_bf16_f32 v152, v80, v81
  v_cvt_pk_bf16_f32 v153, v82, v83
  v_mfma_f32_32x32x16_bf16 v[120:135], v[60:63], v[160:163], v[120:135]
  global_load_dwordx4 v[56:59], v3, s[24:25]
  global_load_dwordx4 v[60:63], v3, s[24:25] offset:1024
  s_add_u32 s24, s24, 2048
  s_addc_u32 s25, s25, 0
  v_exp_f32 v84, v84
  v_exp_f32 v85, v85
  v_exp_f32 v86, v86
  v_exp_f32 v87, v87
  v_cvt_pk_bf16_f32 v154, v84, v85
  v_cvt_pk_bf16_f32 v155, v86, v87
  v_mfma_f32_32x32x16_bf16 v[72:87], v[40:43], v[8:11], 0
  v_exp_f32 v88, v88
  v_exp_f32 v89, v89
  v_exp_f32 v90, v90
  v_exp_f32 v91, v91
  v_cvt_pk_bf16_f32 v156, v88, v89
  v_cvt_pk_bf16_f32 v157, v90, v91
  v_mfma_f32_32x32x16_bf16 v[72:87], v[44:47], v[12:15], v[72:87]
  v_exp_f32 v92, v92
  v_exp_f32 v93, v93
  v_exp_f32 v94, v94
  v_exp_f32 v95, v95
  v_cvt_pk_bf16_f32 v158, v92, v93
  v_cvt_pk_bf16_f32 v159, v94, v95
  s_waitcnt vmcnt(2)
  v_mfma_f32_32x32x16_bf16 v[104:119], v[64:67], v[148:151], v[104:119]
  v_exp_f32 v96, v96
  v_exp_f32 v97, v97
  v_exp_f32 v98, v98
  v_exp_f32 v99, v99
  v_cvt_pk_bf16_f32 v160, v96, v97
  v_cvt_pk_bf16_f32 v161, v98, v99
  v_mfma_f32_32x32x16_bf16 v[104:119], v[68:71], v[152:155], v[104:119]
  v_exp_f32 v100, v100
  v_exp_f32 v101, v101
  v_exp_f32 v102, v102
  v_exp_f32 v103, v103
  v_cvt_pk_bf16_f32 v162, v100, v101
  v_cvt_pk_bf16_f32 v163, v102, v103
  v_mfma_f32_32x32x16_bf16 v[88:103], v[40:43], v[16:19], 0
  v_exp_f32 v72, v72
  v_exp_f32 v73, v73
  v_exp_f32 v74, v74
  v_exp_f32 v75, v75
  v_cvt_pk_bf16_f32 v148, v72, v73
  v_cvt_pk_bf16_f32 v149, v74, v75
  v_mfma_f32_32x32x16_bf16 v[88:103], v[44:47], v[20:23], v[88:103]
  v_exp_f32 v76, v76
  v_exp_f32 v77, v77
  v_exp_f32 v78, v78
  v_exp_f32 v79, v79
  v_cvt_pk_bf16_f32 v150, v76, v77
  v_cvt_pk_bf16_f32 v151, v78, v79
  v_mfma_f32_32x32x16_bf16 v[120:135], v[64:67], v[156:159], v[120:135]
  v_exp_f32 v80, v80
  v_exp_f32 v81, v81
  v_exp_f32 v82, v82
  v_exp_f32 v83, v83
  v_cvt_pk_bf16_f32 v152, v80, v81
  v_cvt_pk_bf16_f32 v153, v82, v83
  v_mfma_f32_32x32x16_bf16 v[120:135], v[68:71], v[160:163], v[120:135]
  global_load_dwordx4 v[64:67], v3, s[24:25]
  global_load_dwordx4 v[68:71], v3, s[24:25] offset:1024
  s_add_u32 s24, s24, 2048
  s_addc_u32 s25, s25, 0
  v_exp_f32 v84, v84
  v_exp_f32 v85, v85
  v_exp_f32 v86, v86
  v_exp_f32 v87, v87
  v_cvt_pk_bf16_f32 v154, v84, v85
  v_cvt_pk_bf16_f32 v155, v86, v87
  v_mfma_f32_32x32x16_bf16 v[72:87], v[48:51], v[8:11], 0
  v_exp_f32 v88, v88
  v_exp_f32 v89, v89
  v_exp_f32 v90, v90
  v_exp_f32 v91, v91
  v_cvt_pk_bf16_f32 v156, v88, v89
  v_cvt_pk_bf16_f32 v157, v90, v91
  v_mfma_f32_32x32x16_bf16 v[72:87], v[52:55], v[12:15], v[72:87]
  v_exp_f32 v92, v92
  v_exp_f32 v93, v93
  v_exp_f32 v94, v94
  v_exp_f32 v95, v95
  v_cvt_pk_bf16_f32 v158, v92, v93
  v_cvt_pk_bf16_f32 v159, v94, v95
  s_waitcnt vmcnt(2)
  v_mfma_f32_32x32x16_bf16 v[104:119], v[56:59], v[148:151], v[104:119]
  v_exp_f32 v96, v96
  v_exp_f32 v97, v97
  v_exp_f32 v98, v98
  v_exp_f32 v99, v99
  v_cvt_pk_bf16_f32 v160, v96, v97
  v_cvt_pk_bf16_f32 v161, v98, v99
  v_mfma_f32_32x32x16_bf16 v[104:119], v[60:63], v[152:155], v[104:119]
  v_exp_f32 v100, v100
  v_exp_f32 v101, v101
  v_exp_f32 v102, v102
  v_exp_f32 v103, v103
  v_cvt_pk_bf16_f32 v162, v100, v101
  v_cvt_pk_bf16_f32 v163, v102, v103
  v_mfma_f32_32x32x16_bf16 v[88:103], v[48:51], v[16:19], 0
  v_exp_f32 v72, v72
  v_exp_f32 v73, v73
  v_exp_f32 v74, v74
  v_exp_f32 v75, v75
  v_cvt_pk_bf16_f32 v148, v72, v73
  v_cvt_pk_bf16_f32 v149, v74, v75
  v_mfma_f32_32x32x16_bf16 v[88:103], v[52:55], v[20:23], v[88:103]
  v_exp_f32 v76, v76
  v_exp_f32 v77, v77
  v_exp_f32 v78, v78
  v_exp_f32 v79, v79
  v_cvt_pk_bf16_f32 v150, v76, v77
  v_cvt_pk_bf16_f32 v151, v78, v79
  v_mfma_f32_32x32x16_bf16 v[120:135], v[56:59], v[156:159], v[120:135]
  v_exp_f32 v80, v80
  v_exp_f32 v81, v81
  v_exp_f32 v82, v82
  v_exp_f32 v83, v83
  v_cvt_pk_bf16_f32 v152, v80, v81
  v_cvt_pk_bf16_f32 v153, v82, v83
  v_mfma_f32_32x32x16_bf16 v[120:135], v[60:63], v[160:163], v[120:135]
  v_exp_f32 v84, v84
  v_exp_f32 v85, v85
  v_exp_f32 v86, v86
  v_exp_f32 v87, v87
  v_cvt_pk_bf16_f32 v154, v84, v85
  v_cvt_pk_bf16_f32 v155, v86, v87
  v_exp_f32 v88, v88
  v_exp_f32 v89, v89
  v_exp_f32 v90, v90
  v_exp_f32 v91, v91
  v_cvt_pk_bf16_f32 v156, v88, v89
  v_cvt_pk_bf16_f32 v157, v90, v91
  v_exp_f32 v92, v92
  v_exp_f32 v93, v93
  v_exp_f32 v94, v94
  v_exp_f32 v95, v95
  v_cvt_pk_bf16_f32 v158, v92, v93
  v_cvt_pk_bf16_f32 v159, v94, v95
  s_waitcnt vmcnt(0)
  v_mfma_f32_32x32x16_bf16 v[104:119], v[64:67], v[148:151], v[104:119]
  v_exp_f32 v96, v96
  v_exp_f32 v97, v97
  v_exp_f32 v98, v98
  v_exp_f32 v99, v99
  v_cvt_pk_bf16_f32 v160, v96, v97
  v_cvt_pk_bf16_f32 v161, v98, v99
  v_mfma_f32_32x32x16_bf16 v[104:119], v[68:71], v[152:155], v[104:119]
  v_exp_f32 v100, v100
  v_exp_f32 v101, v101
  v_exp_f32 v102, v102
  v_exp_f32 v103, v103
  v_cvt_pk_bf16_f32 v162, v100, v101
  v_cvt_pk_bf16_f32 v163, v102, v103
  s_nop 1
  v_mfma_f32_32x32x16_bf16 v[120:135], v[64:67], v[156:159], v[120:135]
  v_mfma_f32_32x32x16_bf16 v[120:135], v[68:71], v[160:163], v[120:135]
  s_nop 15
  s_nop 15
  s_lshl_b32 s17, s14, 13
  v_add_u32 v4, s17, v3
  ds_write_b128 v4, v[104:107] offset:0
  ds_write_b128 v4, v[108:111] offset:1024
  ds_write_b128 v4, v[112:115] offset:2048
  ds_write_b128 v4, v[116:119] offset:3072
  ds_write_b128 v4, v[120:123] offset:4096
  ds_write_b128 v4, v[124:127] offset:5120
  ds_write_b128 v4, v[128:131] offset:6144
  ds_write_b128 v4, v[132:135] offset:7168
  s_lshl_b32 s17, s14, 9
  v_lshl_add_u32 v5, v2, 2, s17
  ds_write_b32 v5, v136 offset:32768
  ds_write_b32 v5, v137 offset:33024
  s_waitcnt lgkmcnt(0)
  s_barrier
  s_lshr_b32 s17, s14, 1
  s_and_b32 s18, s14, 1
  s_lshl_b32 s19, s17, 8
  v_lshl_add_u32 v5, v2, 2, s19
  ds_read_b32 v8, v5 offset:32768
  ds_read_b32 v9, v5 offset:33280
  ds_read_b32 v10, v5 offset:33792
  ds_read_b32 v11, v5 offset:34304
  s_lshl_b32 s19, s17, 12
  s_lshl_b32 s28, s18, 11
  s_add_u32 s19, s19, s28
  v_add_u32 v4, s19, v3
  v_and_b32 v6, 31, v2
  v_lshlrev_b32 v6, 4, v6
  s_lshl_b32 s19, s17, 12
  v_add_u32 v6, s19, v6
  ds_read_b128 v[16:19], v4 offset:0
  ds_read_b128 v[20:23], v4 offset:1024
  ds_read_b32 v12, v6 offset:3584
  ds_read_b128 v[24:27], v4 offset:8192
  ds_read_b128 v[28:31], v4 offset:9216
  ds_read_b32 v13, v6 offset:11776
  ds_read_b128 v[32:35], v4 offset:16384
  ds_read_b128 v[36:39], v4 offset:17408
  ds_read_b32 v14, v6 offset:19968
  ds_read_b128 v[40:43], v4 offset:24576
  ds_read_b128 v[44:47], v4 offset:25600
  ds_read_b32 v15, v6 offset:28160
  s_waitcnt lgkmcnt(0)
  v_max3_f32 v48, v8, v9, v10
  v_max_f32 v48, v48, v11
  v_sub_f32 v8, v8, v48
  v_sub_f32 v9, v9, v48
  v_sub_f32 v10, v10, v48
  v_sub_f32 v11, v11, v48
  v_exp_f32 v8, v8
  v_exp_f32 v9, v9
  v_exp_f32 v10, v10
  v_exp_f32 v11, v11
  s_nop 0
  v_mul_f32 v49, v8, v12
  v_fmac_f32 v49, v9, v13
  v_fmac_f32 v49, v10, v14
  v_fmac_f32 v49, v11, v15
  v_mul_f32 v50, v8, v16
  v_fmac_f32 v50, v9, v24
  v_fmac_f32 v50, v10, v32
  v_fmac_f32 v50, v11, v40
  v_mul_f32 v51, v8, v17
  v_fmac_f32 v51, v9, v25
  v_fmac_f32 v51, v10, v33
  v_fmac_f32 v51, v11, v41
  v_mul_f32 v52, v8, v18
  v_fmac_f32 v52, v9, v26
  v_fmac_f32 v52, v10, v34
  v_fmac_f32 v52, v11, v42
  v_mul_f32 v53, v8, v19
  v_fmac_f32 v53, v9, v27
  v_fmac_f32 v53, v10, v35
  v_fmac_f32 v53, v11, v43
  v_mul_f32 v54, v8, v20
  v_fmac_f32 v54, v9, v28
  v_fmac_f32 v54, v10, v36
  v_fmac_f32 v54, v11, v44
  v_mul_f32 v55, v8, v21
  v_fmac_f32 v55, v9, v29
  v_fmac_f32 v55, v10, v37
  v_fmac_f32 v55, v11, v45
  v_mul_f32 v56, v8, v22
  v_fmac_f32 v56, v9, v30
  v_fmac_f32 v56, v10, v38
  v_fmac_f32 v56, v11, v46
  v_mul_f32 v57, v8, v23
  v_fmac_f32 v57, v9, v31
  v_fmac_f32 v57, v10, v39
  v_fmac_f32 v57, v11, v47
  v_rcp_f32 v58, v49
  s_nop 0
  v_fma_f32 v59, -v58, v49, 1.0
  v_fma_f32 v58, v59, v58, v58
  v_mul_f32 v50, v58, v50
  v_mul_f32 v51, v58, v51
  v_mul_f32 v52, v58, v52
  v_mul_f32 v53, v58, v53
  v_mul_f32 v54, v58, v54
  v_mul_f32 v55, v58, v55
  v_mul_f32 v56, v58, v56
  v_mul_f32 v57, v58, v57
  v_cvt_pk_bf16_f32 v60, v50, v51
  v_cvt_pk_bf16_f32 v61, v52, v53
  v_cvt_pk_bf16_f32 v62, v54, v55
  v_cvt_pk_bf16_f32 v63, v56, v57
  s_lshl_b32 s19, s16, 1
  s_add_u32 s19, s19, s17
  s_lshl_b32 s19, s19, 5
  s_lshl_b32 s28, s15, 1
  s_add_u32 s19, s19, s28
  s_add_u32 s19, s19, s18
  s_lshl_b32 s19, s19, 10
  s_add_u32 s19, s19, 11862016
  s_add_u32 s20, s12, s19
  s_addc_u32 s21, s13, 0
  global_store_dwordx4 v3, v[60:63], s[20:21]
  s_branch K2_end
K2_red:
  v_lshlrev_b32 v4, 4, v0
  v_cmp_gt_u32 vcc, 112, v0
  s_and_saveexec_b64 s[24:25], vcc
  s_cbranch_execz K2R_done
  s_waitcnt lgkmcnt(0)
  s_add_u32 s20, s12, 14092032
  s_addc_u32 s21, s13, 0
  v_mov_b32 v5, 0
  global_load_dword v6, v5, s[20:21]
  v_mov_b32 v8, 0
  v_mov_b32 v9, 0
  v_mov_b32 v10, 0
  v_mov_b32 v11, 0
  s_add_u32 s20, s12, 13959168
  s_addc_u32 s21, s13, 0
  global_load_dwordx4 v[16:19], v4, s[20:21]
  s_add_u32 s20, s12, 13960960
  s_addc_u32 s21, s13, 0
  global_load_dwordx4 v[20:23], v4, s[20:21]
  s_add_u32 s20, s12, 13962752
  s_addc_u32 s21, s13, 0
  global_load_dwordx4 v[24:27], v4, s[20:21]
  s_add_u32 s20, s12, 13964544
  s_addc_u32 s21, s13, 0
  global_load_dwordx4 v[28:31], v4, s[20:21]
  s_add_u32 s20, s12, 13966336
  s_addc_u32 s21, s13, 0
  global_load_dwordx4 v[32:35], v4, s[20:21]
  s_add_u32 s20, s12, 13968128
  s_addc_u32 s21, s13, 0
  global_load_dwordx4 v[36:39], v4, s[20:21]
  s_add_u32 s20, s12, 13969920
  s_addc_u32 s21, s13, 0
  global_load_dwordx4 v[40:43], v4, s[20:21]
  s_add_u32 s20, s12, 13971712
  s_addc_u32 s21, s13, 0
  global_load_dwordx4 v[44:47], v4, s[20:21]
  s_add_u32 s20, s12, 13973504
  s_addc_u32 s21, s13, 0
  global_load_dwordx4 v[48:51], v4, s[20:21]
  s_add_u32 s20, s12, 13975296
  s_addc_u32 s21, s13, 0
  global_load_dwordx4 v[52:55], v4, s[20:21]
  s_add_u32 s20, s12, 13977088
  s_addc_u32 s21, s13, 0
  global_load_dwordx4 v[56:59], v4, s[20:21]
  s_add_u32 s20, s12, 13978880
  s_addc_u32 s21, s13, 0
  global_load_dwordx4 v[60:63], v4, s[20:21]
  s_add_u32 s20, s12, 13980672
  s_addc_u32 s21, s13, 0
  global_load_dwordx4 v[64:67], v4, s[20:21]
  s_add_u32 s20, s12, 13982464
  s_addc_u32 s21, s13, 0
  global_load_dwordx4 v[68:71], v4, s[20:21]
  s_waitcnt vmcnt(14)
  v_lshlrev_b32 v6, 2, v6
  s_add_u32 s20, s12, 3670016
  s_addc_u32 s21, s13, 0
  global_load_dword v7, v6, s[20:21]
  s_waitcnt vmcnt(0)
  v_add_f32 v8, v8, v16
  v_add_f32 v9, v9, v17
  v_add_f32 v10, v10, v18
  v_add_f32 v11, v11, v19
  v_add_f32 v8, v8, v20
  v_add_f32 v9, v9, v21
  v_add_f32 v10, v10, v22
  v_add_f32 v11, v11, v23
  v_add_f32 v8, v8, v24
  v_add_f32 v9, v9, v25
  v_add_f32 v10, v10, v26
  v_add_f32 v11, v11, v27
  v_add_f32 v8, v8, v28
  v_add_f32 v9, v9, v29
  v_add_f32 v10, v10, v30
  v_add_f32 v11, v11, v31
  v_add_f32 v8, v8, v32
  v_add_f32 v9, v9, v33
  v_add_f32 v10, v10, v34
  v_add_f32 v11, v11, v35
  v_add_f32 v8, v8, v36
  v_add_f32 v9, v9, v37
  v_add_f32 v10, v10, v38
  v_add_f32 v11, v11, v39
  v_add_f32 v8, v8, v40
  v_add_f32 v9, v9, v41
  v_add_f32 v10, v10, v42
  v_add_f32 v11, v11, v43
  v_add_f32 v8, v8, v44
  v_add_f32 v9, v9, v45
  v_add_f32 v10, v10, v46
  v_add_f32 v11, v11, v47
  v_add_f32 v8, v8, v48
  v_add_f32 v9, v9, v49
  v_add_f32 v10, v10, v50
  v_add_f32 v11, v11, v51
  v_add_f32 v8, v8, v52
  v_add_f32 v9, v9, v53
  v_add_f32 v10, v10, v54
  v_add_f32 v11, v11, v55
  v_add_f32 v8, v8, v56
  v_add_f32 v9, v9, v57
  v_add_f32 v10, v10, v58
  v_add_f32 v11, v11, v59
  v_add_f32 v8, v8, v60
  v_add_f32 v9, v9, v61
  v_add_f32 v10, v10, v62
  v_add_f32 v11, v11, v63
  v_add_f32 v8, v8, v64
  v_add_f32 v9, v9, v65
  v_add_f32 v10, v10, v66
  v_add_f32 v11, v11, v67
  v_add_f32 v8, v8, v68
  v_add_f32 v9, v9, v69
  v_add_f32 v10, v10, v70
  v_add_f32 v11, v11, v71
  s_add_u32 s20, s12, 13984256
  s_addc_u32 s21, s13, 0
  global_load_dwordx4 v[16:19], v4, s[20:21]
  s_add_u32 s20, s12, 13986048
  s_addc_u32 s21, s13, 0
  global_load_dwordx4 v[20:23], v4, s[20:21]
  s_add_u32 s20, s12, 13987840
  s_addc_u32 s21, s13, 0
  global_load_dwordx4 v[24:27], v4, s[20:21]
  s_add_u32 s20, s12, 13989632
  s_addc_u32 s21, s13, 0
  global_load_dwordx4 v[28:31], v4, s[20:21]
  s_add_u32 s20, s12, 13991424
  s_addc_u32 s21, s13, 0
  global_load_dwordx4 v[32:35], v4, s[20:21]
  s_add_u32 s20, s12, 13993216
  s_addc_u32 s21, s13, 0
  global_load_dwordx4 v[36:39], v4, s[20:21]
  s_add_u32 s20, s12, 13995008
  s_addc_u32 s21, s13, 0
  global_load_dwordx4 v[40:43], v4, s[20:21]
  s_add_u32 s20, s12, 13996800
  s_addc_u32 s21, s13, 0
  global_load_dwordx4 v[44:47], v4, s[20:21]
  s_add_u32 s20, s12, 13998592
  s_addc_u32 s21, s13, 0
  global_load_dwordx4 v[48:51], v4, s[20:21]
  s_add_u32 s20, s12, 14000384
  s_addc_u32 s21, s13, 0
  global_load_dwordx4 v[52:55], v4, s[20:21]
  s_add_u32 s20, s12, 14002176
  s_addc_u32 s21, s13, 0
  global_load_dwordx4 v[56:59], v4, s[20:21]
  s_add_u32 s20, s12, 14003968
  s_addc_u32 s21, s13, 0
  global_load_dwordx4 v[60:63], v4, s[20:21]
  s_add_u32 s20, s12, 14005760
  s_addc_u32 s21, s13, 0
  global_load_dwordx4 v[64:67], v4, s[20:21]
  s_add_u32 s20, s12, 14007552
  s_addc_u32 s21, s13, 0
  global_load_dwordx4 v[68:71], v4, s[20:21]
  s_waitcnt vmcnt(0)
  v_add_f32 v8, v8, v16
  v_add_f32 v9, v9, v17
  v_add_f32 v10, v10, v18
  v_add_f32 v11, v11, v19
  v_add_f32 v8, v8, v20
  v_add_f32 v9, v9, v21
  v_add_f32 v10, v10, v22
  v_add_f32 v11, v11, v23
  v_add_f32 v8, v8, v24
  v_add_f32 v9, v9, v25
  v_add_f32 v10, v10, v26
  v_add_f32 v11, v11, v27
  v_add_f32 v8, v8, v28
  v_add_f32 v9, v9, v29
  v_add_f32 v10, v10, v30
  v_add_f32 v11, v11, v31
  v_add_f32 v8, v8, v32
  v_add_f32 v9, v9, v33
  v_add_f32 v10, v10, v34
  v_add_f32 v11, v11, v35
  v_add_f32 v8, v8, v36
  v_add_f32 v9, v9, v37
  v_add_f32 v10, v10, v38
  v_add_f32 v11, v11, v39
  v_add_f32 v8, v8, v40
  v_add_f32 v9, v9, v41
  v_add_f32 v10, v10, v42
  v_add_f32 v11, v11, v43
  v_add_f32 v8, v8, v44
  v_add_f32 v9, v9, v45
  v_add_f32 v10, v10, v46
  v_add_f32 v11, v11, v47
  v_add_f32 v8, v8, v48
  v_add_f32 v9, v9, v49
  v_add_f32 v10, v10, v50
  v_add_f32 v11, v11, v51
  v_add_f32 v8, v8, v52
  v_add_f32 v9, v9, v53
  v_add_f32 v10, v10, v54
  v_add_f32 v11, v11, v55
  v_add_f32 v8, v8, v56
  v_add_f32 v9, v9, v57
  v_add_f32 v10, v10, v58
  v_add_f32 v11, v11, v59
  v_add_f32 v8, v8, v60
  v_add_f32 v9, v9, v61
  v_add_f32 v10, v10, v62
  v_add_f32 v11, v11, v63
  v_add_f32 v8, v8, v64
  v_add_f32 v9, v9, v65
  v_add_f32 v10, v10, v66
  v_add_f32 v11, v11, v67
  v_add_f32 v8, v8, v68
  v_add_f32 v9, v9, v69
  v_add_f32 v10, v10, v70
  v_add_f32 v11, v11, v71
  s_add_u32 s20, s12, 14009344
  s_addc_u32 s21, s13, 0
  global_load_dwordx4 v[16:19], v4, s[20:21]
  s_add_u32 s20, s12, 14011136
  s_addc_u32 s21, s13, 0
  global_load_dwordx4 v[20:23], v4, s[20:21]
  s_add_u32 s20, s12, 14012928
  s_addc_u32 s21, s13, 0
  global_load_dwordx4 v[24:27], v4, s[20:21]
  s_add_u32 s20, s12, 14014720
  s_addc_u32 s21, s13, 0
  global_load_dwordx4 v[28:31], v4, s[20:21]
  s_add_u32 s20, s12, 14016512
  s_addc_u32 s21, s13, 0
  global_load_dwordx4 v[32:35], v4, s[20:21]
  s_add_u32 s20, s12, 14018304
  s_addc_u32 s21, s13, 0
  global_load_dwordx4 v[36:39], v4, s[20:21]
  s_add_u32 s20, s12, 14020096
  s_addc_u32 s21, s13, 0
  global_load_dwordx4 v[40:43], v4, s[20:21]
  s_add_u32 s20, s12, 14021888
  s_addc_u32 s21, s13, 0
  global_load_dwordx4 v[44:47], v4, s[20:21]
  s_add_u32 s20, s12, 14023680
  s_addc_u32 s21, s13, 0
  global_load_dwordx4 v[48:51], v4, s[20:21]
  s_add_u32 s20, s12, 14025472
  s_addc_u32 s21, s13, 0
  global_load_dwordx4 v[52:55], v4, s[20:21]
  s_add_u32 s20, s12, 14027264
  s_addc_u32 s21, s13, 0
  global_load_dwordx4 v[56:59], v4, s[20:21]
  s_add_u32 s20, s12, 14029056
  s_addc_u32 s21, s13, 0
  global_load_dwordx4 v[60:63], v4, s[20:21]
  s_add_u32 s20, s12, 14030848
  s_addc_u32 s21, s13, 0
  global_load_dwordx4 v[64:67], v4, s[20:21]
  s_add_u32 s20, s12, 14032640
  s_addc_u32 s21, s13, 0
  global_load_dwordx4 v[68:71], v4, s[20:21]
  s_waitcnt vmcnt(0)
  v_add_f32 v8, v8, v16
  v_add_f32 v9, v9, v17
  v_add_f32 v10, v10, v18
  v_add_f32 v11, v11, v19
  v_add_f32 v8, v8, v20
  v_add_f32 v9, v9, v21
  v_add_f32 v10, v10, v22
  v_add_f32 v11, v11, v23
  v_add_f32 v8, v8, v24
  v_add_f32 v9, v9, v25
  v_add_f32 v10, v10, v26
  v_add_f32 v11, v11, v27
  v_add_f32 v8, v8, v28
  v_add_f32 v9, v9, v29
  v_add_f32 v10, v10, v30
  v_add_f32 v11, v11, v31
  v_add_f32 v8, v8, v32
  v_add_f32 v9, v9, v33
  v_add_f32 v10, v10, v34
  v_add_f32 v11, v11, v35
  v_add_f32 v8, v8, v36
  v_add_f32 v9, v9, v37
  v_add_f32 v10, v10, v38
  v_add_f32 v11, v11, v39
  v_add_f32 v8, v8, v40
  v_add_f32 v9, v9, v41
  v_add_f32 v10, v10, v42
  v_add_f32 v11, v11, v43
  v_add_f32 v8, v8, v44
  v_add_f32 v9, v9, v45
  v_add_f32 v10, v10, v46
  v_add_f32 v11, v11, v47
  v_add_f32 v8, v8, v48
  v_add_f32 v9, v9, v49
  v_add_f32 v10, v10, v50
  v_add_f32 v11, v11, v51
  v_add_f32 v8, v8, v52
  v_add_f32 v9, v9, v53
  v_add_f32 v10, v10, v54
  v_add_f32 v11, v11, v55
  v_add_f32 v8, v8, v56
  v_add_f32 v9, v9, v57
  v_add_f32 v10, v10, v58
  v_add_f32 v11, v11, v59
  v_add_f32 v8, v8, v60
  v_add_f32 v9, v9, v61
  v_add_f32 v10, v10, v62
  v_add_f32 v11, v11, v63
  v_add_f32 v8, v8, v64
  v_add_f32 v9, v9, v65
  v_add_f32 v10, v10, v66
  v_add_f32 v11, v11, v67
  v_add_f32 v8, v8, v68
  v_add_f32 v9, v9, v69
  v_add_f32 v10, v10, v70
  v_add_f32 v11, v11, v71
  s_add_u32 s20, s12, 14034432
  s_addc_u32 s21, s13, 0
  global_load_dwordx4 v[16:19], v4, s[20:21]
  s_add_u32 s20, s12, 14036224
  s_addc_u32 s21, s13, 0
  global_load_dwordx4 v[20:23], v4, s[20:21]
  s_add_u32 s20, s12, 14038016
  s_addc_u32 s21, s13, 0
  global_load_dwordx4 v[24:27], v4, s[20:21]
  s_add_u32 s20, s12, 14039808
  s_addc_u32 s21, s13, 0
  global_load_dwordx4 v[28:31], v4, s[20:21]
  s_add_u32 s20, s12, 14041600
  s_addc_u32 s21, s13, 0
  global_load_dwordx4 v[32:35], v4, s[20:21]
  s_add_u32 s20, s12, 14043392
  s_addc_u32 s21, s13, 0
  global_load_dwordx4 v[36:39], v4, s[20:21]
  s_add_u32 s20, s12, 14045184
  s_addc_u32 s21, s13, 0
  global_load_dwordx4 v[40:43], v4, s[20:21]
  s_add_u32 s20, s12, 14046976
  s_addc_u32 s21, s13, 0
  global_load_dwordx4 v[44:47], v4, s[20:21]
  s_add_u32 s20, s12, 14048768
  s_addc_u32 s21, s13, 0
  global_load_dwordx4 v[48:51], v4, s[20:21]
  s_add_u32 s20, s12, 14050560
  s_addc_u32 s21, s13, 0
  global_load_dwordx4 v[52:55], v4, s[20:21]
  s_add_u32 s20, s12, 14052352
  s_addc_u32 s21, s13, 0
  global_load_dwordx4 v[56:59], v4, s[20:21]
  s_add_u32 s20, s12, 14054144
  s_addc_u32 s21, s13, 0
  global_load_dwordx4 v[60:63], v4, s[20:21]
  s_add_u32 s20, s12, 14055936
  s_addc_u32 s21, s13, 0
  global_load_dwordx4 v[64:67], v4, s[20:21]
  s_add_u32 s20, s12, 14057728
  s_addc_u32 s21, s13, 0
  global_load_dwordx4 v[68:71], v4, s[20:21]
  s_waitcnt vmcnt(0)
  v_add_f32 v8, v8, v16
  v_add_f32 v9, v9, v17
  v_add_f32 v10, v10, v18
  v_add_f32 v11, v11, v19
  v_add_f32 v8, v8, v20
  v_add_f32 v9, v9, v21
  v_add_f32 v10, v10, v22
  v_add_f32 v11, v11, v23
  v_add_f32 v8, v8, v24
  v_add_f32 v9, v9, v25
  v_add_f32 v10, v10, v26
  v_add_f32 v11, v11, v27
  v_add_f32 v8, v8, v28
  v_add_f32 v9, v9, v29
  v_add_f32 v10, v10, v30
  v_add_f32 v11, v11, v31
  v_add_f32 v8, v8, v32
  v_add_f32 v9, v9, v33
  v_add_f32 v10, v10, v34
  v_add_f32 v11, v11, v35
  v_add_f32 v8, v8, v36
  v_add_f32 v9, v9, v37
  v_add_f32 v10, v10, v38
  v_add_f32 v11, v11, v39
  v_add_f32 v8, v8, v40
  v_add_f32 v9, v9, v41
  v_add_f32 v10, v10, v42
  v_add_f32 v11, v11, v43
  v_add_f32 v8, v8, v44
  v_add_f32 v9, v9, v45
  v_add_f32 v10, v10, v46
  v_add_f32 v11, v11, v47
  v_add_f32 v8, v8, v48
  v_add_f32 v9, v9, v49
  v_add_f32 v10, v10, v50
  v_add_f32 v11, v11, v51
  v_add_f32 v8, v8, v52
  v_add_f32 v9, v9, v53
  v_add_f32 v10, v10, v54
  v_add_f32 v11, v11, v55
  v_add_f32 v8, v8, v56
  v_add_f32 v9, v9, v57
  v_add_f32 v10, v10, v58
  v_add_f32 v11, v11, v59
  v_add_f32 v8, v8, v60
  v_add_f32 v9, v9, v61
  v_add_f32 v10, v10, v62
  v_add_f32 v11, v11, v63
  v_add_f32 v8, v8, v64
  v_add_f32 v9, v9, v65
  v_add_f32 v10, v10, v66
  v_add_f32 v11, v11, v67
  v_add_f32 v8, v8, v68
  v_add_f32 v9, v9, v69
  v_add_f32 v10, v10, v70
  v_add_f32 v11, v11, v71
  v_cvt_pk_bf16_f32 v7, v7, v7
  v_lshlrev_b32 v7, 16, v7
  v_mul_f32 v12, 0xbfb8aa3b, v7
  v_exp_f32 v12, v12
  s_nop 0
  v_add_f32 v12, 1.0, v12
  v_rcp_f32 v13, v12
  s_nop 0
  v_fma_f32 v14, -v13, v12, 1.0
  v_fma_f32 v13, v14, v13, v13
  v_cvt_pk_bf16_f32 v13, v13, v13
  v_lshlrev_b32 v13, 16, v13
  v_cvt_pk_bf16_f32 v16, v8, v9
  v_cvt_pk_bf16_f32 v17, v10, v11
  v_lshlrev_b32 v8, 16, v16
  v_and_b32 v9, 0xffff0000, v16
  v_lshlrev_b32 v10, 16, v17
  v_and_b32 v11, 0xffff0000, v17
  v_mul_f32 v8, v8, v13
  v_mul_f32 v9, v9, v13
  v_mul_f32 v10, v10, v13
  v_mul_f32 v11, v11, v13
  v_cvt_pk_bf16_f32 v16, v8, v9
  v_cvt_pk_bf16_f32 v17, v10, v11
  v_lshlrev_b32 v8, 16, v16
  v_and_b32 v9, 0xffff0000, v16
  v_lshlrev_b32 v10, 16, v17
  v_and_b32 v11, 0xffff0000, v17
  s_add_u32 s20, s12, 14090240
  s_addc_u32 s21, s13, 0
  global_store_dwordx4 v4, v[8:11], s[20:21]
K2R_done:
K2_end:
  s_endpgm
.globl k3_out_kernel
.p2align 8
.type k3_out_kernel,@function
k3_out_kernel:
  s_cmp_ge_u32 s2, 224
  s_cbranch_scc1 K3_end
  s_load_dwordx2 s[4:5], s[0:1], 0
  s_load_dwordx2 s[6:7], s[0:1], 64
  s_load_dwordx2 s[12:13], s[0:1], 80
  v_lshrrev_b32 v1, 6, v0
  v_and_b32 v2, 63, v0
  v_lshlrev_b32 v3, 4, v2
  v_readfirstlane_b32 s14, v1
  s_lshl_b32 s15, s2, 2
  s_add_u32 s15, s15, s14
  s_mov_b32 s16, 306783379
  s_mul_hi_u32 s16, s15, s16
  s_mul_i32 s17, s16, 14
  s_sub_u32 s17, s15, s17
  s_waitcnt lgkmcnt(0)
  s_lshl_b32 s18, s16, 15
  s_add_u32 s18, s18, 11862016
  s_add_u32 s20, s12, s18
  s_addc_u32 s21, s13, 0
  s_lshl_b32 s18, s17, 15
  s_add_u32 s18, s18, 5111808
  s_add_u32 s22, s12, s18
  s_addc_u32 s23, s13, 0
  v_and_b32 v4, 31, v2
  v_lshrrev_b32 v5, 5, v2
  s_lshl_b32 s18, s16, 5
  v_add_u32 v6, s18, v4
  v_mul_u32_u24 v7, 896, v6
  s_lshl_b32 s18, s17, 6
  v_lshl_add_u32 v7, v5, 3, v7
  v_add_u32 v7, s18, v7
  v_lshlrev_b32 v8, 4, v5
  s_lshl_b32 s18, s17, 7
  v_add_u32 v8, s18, v8
  s_add_u32 s24, s12, 1835008
  s_addc_u32 s25, s13, 0
  s_add_u32 s26, s12, 14090240
  s_addc_u32 s27, s13, 0
  v_mov_b32 v9, 0
  global_load_dword v10, v9, s[26:27] offset:1792
  global_load_dwordx2 v[128:129], v7, s[4:5] offset:0
  global_load_dwordx2 v[136:137], v7, s[24:25] offset:0
  global_load_dwordx4 v[144:147], v8, s[26:27] offset:0
  global_load_dwordx2 v[130:131], v7, s[4:5] offset:16
  global_load_dwordx2 v[138:139], v7, s[24:25] offset:16
  global_load_dwordx4 v[148:151], v8, s[26:27] offset:32
  global_load_dwordx2 v[132:133], v7, s[4:5] offset:32
  global_load_dwordx2 v[140:141], v7, s[24:25] offset:32
  global_load_dwordx4 v[152:155], v8, s[26:27] offset:64
  global_load_dwordx2 v[134:135], v7, s[4:5] offset:48
  global_load_dwordx2 v[142:143], v7, s[24:25] offset:48
  global_load_dwordx4 v[156:159], v8, s[26:27] offset:96
  global_load_dwordx4 v[32:35], v3, s[20:21] offset:0
  global_load_dwordx4 v[36:39], v3, s[22:23] offset:0
  global_load_dwordx4 v[40:43], v3, s[20:21] offset:1024
  global_load_dwordx4 v[44:47], v3, s[22:23] offset:1024
  global_load_dwordx4 v[48:51], v3, s[20:21] offset:2048
  global_load_dwordx4 v[52:55], v3, s[22:23] offset:2048
  global_load_dwordx4 v[56:59], v3, s[20:21] offset:3072
  global_load_dwordx4 v[60:63], v3, s[22:23] offset:3072
  s_add_u32 s20, s20, 4096
  s_addc_u32 s21, s21, 0
  s_add_u32 s22, s22, 4096
  s_addc_u32 s23, s23, 0
  global_load_dwordx4 v[64:67], v3, s[20:21] offset:0
  global_load_dwordx4 v[68:71], v3, s[22:23] offset:0
  global_load_dwordx4 v[72:75], v3, s[20:21] offset:1024
  global_load_dwordx4 v[76:79], v3, s[22:23] offset:1024
  global_load_dwordx4 v[80:83], v3, s[20:21] offset:2048
  global_load_dwordx4 v[84:87], v3, s[22:23] offset:2048
  global_load_dwordx4 v[88:91], v3, s[20:21] offset:3072
  global_load_dwordx4 v[92:95], v3, s[22:23] offset:3072
  s_add_u32 s20, s20, 4096
  s_addc_u32 s21, s21, 0
  s_add_u32 s22, s22, 4096
  s_addc_u32 s23, s23, 0
  global_load_dwordx4 v[96:99], v3, s[20:21] offset:0
  global_load_dwordx4 v[100:103], v3, s[22:23] offset:0
  global_load_dwordx4 v[104:107], v3, s[20:21] offset:1024
  global_load_dwordx4 v[108:111], v3, s[22:23] offset:1024
  global_load_dwordx4 v[112:115], v3, s[20:21] offset:2048
  global_load_dwordx4 v[116:119], v3, s[22:23] offset:2048
  global_load_dwordx4 v[120:123], v3, s[20:21] offset:3072
  global_load_dwordx4 v[124:127], v3, s[22:23] offset:3072
  s_waitcnt vmcnt(22)
  v_mfma_f32_32x32x16_bf16 v[16:31], v[36:39], v[32:35], 0
  s_add_u32 s20, s20, 4096
  s_addc_u32 s21, s21, 0
  s_add_u32 s22, s22, 4096
  s_addc_u32 s23, s23, 0
  global_load_dwordx4 v[32:35], v3, s[20:21] offset:0
  global_load_dwordx4 v[36:39], v3, s[22:23] offset:0
  s_waitcnt vmcnt(22)
  v_mfma_f32_32x32x16_bf16 v[16:31], v[44:47], v[40:43], v[16:31]
  global_load_dwordx4 v[40:43], v3, s[20:21] offset:1024
  global_load_dwordx4 v[44:47], v3, s[22:23] offset:1024
  s_waitcnt vmcnt(22)
  v_mfma_f32_32x32x16_bf16 v[16:31], v[52:55], v[48:51], v[16:31]
  global_load_dwordx4 v[48:51], v3, s[20:21] offset:2048
  global_load_dwordx4 v[52:55], v3, s[22:23] offset:2048
  s_waitcnt vmcnt(22)
  v_mfma_f32_32x32x16_bf16 v[16:31], v[60:63], v[56:59], v[16:31]
  global_load_dwordx4 v[56:59], v3, s[20:21] offset:3072
  global_load_dwordx4 v[60:63], v3, s[22:23] offset:3072
  s_waitcnt vmcnt(22)
  v_mfma_f32_32x32x16_bf16 v[16:31], v[68:71], v[64:67], v[16:31]
  s_add_u32 s20, s20, 4096
  s_addc_u32 s21, s21, 0
  s_add_u32 s22, s22, 4096
  s_addc_u32 s23, s23, 0
  global_load_dwordx4 v[64:67], v3, s[20:21] offset:0
  global_load_dwordx4 v[68:71], v3, s[22:23] offset:0
  s_waitcnt vmcnt(22)
  v_mfma_f32_32x32x16_bf16 v[16:31], v[76:79], v[72:75], v[16:31]
  global_load_dwordx4 v[72:75], v3, s[20:21] offset:1024
  global_load_dwordx4 v[76:79], v3, s[22:23] offset:1024
  s_waitcnt vmcnt(22)
  v_mfma_f32_32x32x16_bf16 v[16:31], v[84:87], v[80:83], v[16:31]
  global_load_dwordx4 v[80:83], v3, s[20:21] offset:2048
  global_load_dwordx4 v[84:87], v3, s[22:23] offset:2048
  s_waitcnt vmcnt(22)
  v_mfma_f32_32x32x16_bf16 v[16:31], v[92:95], v[88:91], v[16:31]
  global_load_dwordx4 v[88:91], v3, s[20:21] offset:3072
  global_load_dwordx4 v[92:95], v3, s[22:23] offset:3072
  s_waitcnt vmcnt(22)
  v_mfma_f32_32x32x16_bf16 v[16:31], v[100:103], v[96:99], v[16:31]
  s_add_u32 s20, s20, 4096
  s_addc_u32 s21, s21, 0
  s_add_u32 s22, s22, 4096
  s_addc_u32 s23, s23, 0
  global_load_dwordx4 v[96:99], v3, s[20:21] offset:0
  global_load_dwordx4 v[100:103], v3, s[22:23] offset:0
  s_waitcnt vmcnt(22)
  v_mfma_f32_32x32x16_bf16 v[16:31], v[108:111], v[104:107], v[16:31]
  global_load_dwordx4 v[104:107], v3, s[20:21] offset:1024
  global_load_dwordx4 v[108:111], v3, s[22:23] offset:1024
  s_waitcnt vmcnt(22)
  v_mfma_f32_32x32x16_bf16 v[16:31], v[116:119], v[112:115], v[16:31]
  global_load_dwordx4 v[112:115], v3, s[20:21] offset:2048
  global_load_dwordx4 v[116:119], v3, s[22:23] offset:2048
  s_waitcnt vmcnt(22)
  v_mfma_f32_32x32x16_bf16 v[16:31], v[124:127], v[120:123], v[16:31]
  global_load_dwordx4 v[120:123], v3, s[20:21] offset:3072
  global_load_dwordx4 v[124:127], v3, s[22:23] offset:3072
  s_waitcnt vmcnt(22)
  v_mfma_f32_32x32x16_bf16 v[16:31], v[36:39], v[32:35], v[16:31]
  s_add_u32 s20, s20, 4096
  s_addc_u32 s21, s21, 0
  s_add_u32 s22, s22, 4096
  s_addc_u32 s23, s23, 0
  global_load_dwordx4 v[32:35], v3, s[20:21] offset:0
  global_load_dwordx4 v[36:39], v3, s[22:23] offset:0
  s_waitcnt vmcnt(22)
  v_mfma_f32_32x32x16_bf16 v[16:31], v[44:47], v[40:43], v[16:31]
  global_load_dwordx4 v[40:43], v3, s[20:21] offset:1024
  global_load_dwordx4 v[44:47], v3, s[22:23] offset:1024
  s_waitcnt vmcnt(22)
  v_mfma_f32_32x32x16_bf16 v[16:31], v[52:55], v[48:51], v[16:31]
  global_load_dwordx4 v[48:51], v3, s[20:21] offset:2048
  global_load_dwordx4 v[52:55], v3, s[22:23] offset:2048
  s_waitcnt vmcnt(22)
  v_mfma_f32_32x32x16_bf16 v[16:31], v[60:63], v[56:59], v[16:31]
  global_load_dwordx4 v[56:59], v3, s[20:21] offset:3072
  global_load_dwordx4 v[60:63], v3, s[22:23] offset:3072
  s_waitcnt vmcnt(22)
  v_mfma_f32_32x32x16_bf16 v[16:31], v[68:71], v[64:67], v[16:31]
  s_add_u32 s20, s20, 4096
  s_addc_u32 s21, s21, 0
  s_add_u32 s22, s22, 4096
  s_addc_u32 s23, s23, 0
  global_load_dwordx4 v[64:67], v3, s[20:21] offset:0
  global_load_dwordx4 v[68:71], v3, s[22:23] offset:0
  s_waitcnt vmcnt(22)
  v_mfma_f32_32x32x16_bf16 v[16:31], v[76:79], v[72:75], v[16:31]
  global_load_dwordx4 v[72:75], v3, s[20:21] offset:1024
  global_load_dwordx4 v[76:79], v3, s[22:23] offset:1024
  s_waitcnt vmcnt(22)
  v_mfma_f32_32x32x16_bf16 v[16:31], v[84:87], v[80:83], v[16:31]
  global_load_dwordx4 v[80:83], v3, s[20:21] offset:2048
  global_load_dwordx4 v[84:87], v3, s[22:23] offset:2048
  s_waitcnt vmcnt(22)
  v_mfma_f32_32x32x16_bf16 v[16:31], v[92:95], v[88:91], v[16:31]
  global_load_dwordx4 v[88:91], v3, s[20:21] offset:3072
  global_load_dwordx4 v[92:95], v3, s[22:23] offset:3072
  s_waitcnt vmcnt(22)
  v_mfma_f32_32x32x16_bf16 v[16:31], v[100:103], v[96:99], v[16:31]
  s_waitcnt vmcnt(20)
  v_mfma_f32_32x32x16_bf16 v[16:31], v[108:111], v[104:107], v[16:31]
  s_waitcnt vmcnt(18)
  v_mfma_f32_32x32x16_bf16 v[16:31], v[116:119], v[112:115], v[16:31]
  s_waitcnt vmcnt(16)
  v_mfma_f32_32x32x16_bf16 v[16:31], v[124:127], v[120:123], v[16:31]
  s_waitcnt vmcnt(14)
  v_mfma_f32_32x32x16_bf16 v[16:31], v[36:39], v[32:35], v[16:31]
  s_waitcnt vmcnt(12)
  v_mfma_f32_32x32x16_bf16 v[16:31], v[44:47], v[40:43], v[16:31]
  s_waitcnt vmcnt(10)
  v_mfma_f32_32x32x16_bf16 v[16:31], v[52:55], v[48:51], v[16:31]
  s_waitcnt vmcnt(8)
  v_mfma_f32_32x32x16_bf16 v[16:31], v[60:63], v[56:59], v[16:31]
  s_waitcnt vmcnt(6)
  v_mfma_f32_32x32x16_bf16 v[16:31], v[68:71], v[64:67], v[16:31]
  s_waitcnt vmcnt(4)
  v_mfma_f32_32x32x16_bf16 v[16:31], v[76:79], v[72:75], v[16:31]
  s_waitcnt vmcnt(2)
  v_mfma_f32_32x32x16_bf16 v[16:31], v[84:87], v[80:83], v[16:31]
  s_waitcnt vmcnt(0)
  v_mfma_f32_32x32x16_bf16 v[16:31], v[92:95], v[88:91], v[16:31]
  s_nop 7
  s_waitcnt vmcnt(0)
  v_cmp_eq_u32 vcc, v10, v6
  v_cndmask_b32 v144, 0, v144, vcc
  v_cndmask_b32 v145, 0, v145, vcc
  v_cndmask_b32 v146, 0, v146, vcc
  v_cndmask_b32 v147, 0, v147, vcc
  v_cndmask_b32 v148, 0, v148, vcc
  v_cndmask_b32 v149, 0, v149, vcc
  v_cndmask_b32 v150, 0, v150, vcc
  v_cndmask_b32 v151, 0, v151, vcc
  v_cndmask_b32 v152, 0, v152, vcc
  v_cndmask_b32 v153, 0, v153, vcc
  v_cndmask_b32 v154, 0, v154, vcc
  v_cndmask_b32 v155, 0, v155, vcc
  v_cndmask_b32 v156, 0, v156, vcc
  v_cndmask_b32 v157, 0, v157, vcc
  v_cndmask_b32 v158, 0, v158, vcc
  v_cndmask_b32 v159, 0, v159, vcc
  v_lshlrev_b32 v160, 16, v136
  v_and_b32 v161, 0xffff0000, v136
  v_add_f32 v160, v160, v144
  v_add_f32 v161, v161, v145
  v_cvt_pk_bf16_f32 v162, v160, v161
  v_lshlrev_b32 v160, 16, v162
  v_and_b32 v161, 0xffff0000, v162
  v_mul_f32 v163, 0xbfb8aa3b, v160
  v_mul_f32 v164, 0xbfb8aa3b, v161
  v_exp_f32 v163, v163
  v_exp_f32 v164, v164
  s_nop 0
  v_add_f32 v163, 1.0, v163
  v_add_f32 v164, 1.0, v164
  v_rcp_f32 v163, v163
  v_rcp_f32 v164, v164
  s_nop 0
  v_mul_f32 v160, v160, v163
  v_mul_f32 v161, v161, v164
  v_cvt_pk_bf16_f32 v162, v160, v161
  v_lshlrev_b32 v160, 16, v162
  v_and_b32 v161, 0xffff0000, v162
  v_cvt_pk_bf16_f32 v162, v16, v17
  v_lshlrev_b32 v163, 16, v162
  v_and_b32 v164, 0xffff0000, v162
  v_mul_f32 v160, v160, v163
  v_mul_f32 v161, v161, v164
  v_cvt_pk_bf16_f32 v162, v160, v161
  v_lshlrev_b32 v160, 16, v162
  v_and_b32 v161, 0xffff0000, v162
  v_lshlrev_b32 v163, 16, v128
  v_and_b32 v164, 0xffff0000, v128
  v_add_f32 v160, v160, v163
  v_add_f32 v161, v161, v164
  v_cvt_pk_bf16_f32 v166, v160, v161
  v_lshlrev_b32 v160, 16, v137
  v_and_b32 v161, 0xffff0000, v137
  v_add_f32 v160, v160, v146
  v_add_f32 v161, v161, v147
  v_cvt_pk_bf16_f32 v162, v160, v161
  v_lshlrev_b32 v160, 16, v162
  v_and_b32 v161, 0xffff0000, v162
  v_mul_f32 v163, 0xbfb8aa3b, v160
  v_mul_f32 v164, 0xbfb8aa3b, v161
  v_exp_f32 v163, v163
  v_exp_f32 v164, v164
  s_nop 0
  v_add_f32 v163, 1.0, v163
  v_add_f32 v164, 1.0, v164
  v_rcp_f32 v163, v163
  v_rcp_f32 v164, v164
  s_nop 0
  v_mul_f32 v160, v160, v163
  v_mul_f32 v161, v161, v164
  v_cvt_pk_bf16_f32 v162, v160, v161
  v_lshlrev_b32 v160, 16, v162
  v_and_b32 v161, 0xffff0000, v162
  v_cvt_pk_bf16_f32 v162, v18, v19
  v_lshlrev_b32 v163, 16, v162
  v_and_b32 v164, 0xffff0000, v162
  v_mul_f32 v160, v160, v163
  v_mul_f32 v161, v161, v164
  v_cvt_pk_bf16_f32 v162, v160, v161
  v_lshlrev_b32 v160, 16, v162
  v_and_b32 v161, 0xffff0000, v162
  v_lshlrev_b32 v163, 16, v129
  v_and_b32 v164, 0xffff0000, v129
  v_add_f32 v160, v160, v163
  v_add_f32 v161, v161, v164
  v_cvt_pk_bf16_f32 v167, v160, v161
  global_store_dwordx2 v7, v[166:167], s[6:7] offset:0
  s_nop 1
  v_lshlrev_b32 v160, 16, v138
  v_and_b32 v161, 0xffff0000, v138
  v_add_f32 v160, v160, v148
  v_add_f32 v161, v161, v149
  v_cvt_pk_bf16_f32 v162, v160, v161
  v_lshlrev_b32 v160, 16, v162
  v_and_b32 v161, 0xffff0000, v162
  v_mul_f32 v163, 0xbfb8aa3b, v160
  v_mul_f32 v164, 0xbfb8aa3b, v161
  v_exp_f32 v163, v163
  v_exp_f32 v164, v164
  s_nop 0
  v_add_f32 v163, 1.0, v163
  v_add_f32 v164, 1.0, v164
  v_rcp_f32 v163, v163
  v_rcp_f32 v164, v164
  s_nop 0
  v_mul_f32 v160, v160, v163
  v_mul_f32 v161, v161, v164
  v_cvt_pk_bf16_f32 v162, v160, v161
  v_lshlrev_b32 v160, 16, v162
  v_and_b32 v161, 0xffff0000, v162
  v_cvt_pk_bf16_f32 v162, v20, v21
  v_lshlrev_b32 v163, 16, v162
  v_and_b32 v164, 0xffff0000, v162
  v_mul_f32 v160, v160, v163
  v_mul_f32 v161, v161, v164
  v_cvt_pk_bf16_f32 v162, v160, v161
  v_lshlrev_b32 v160, 16, v162
  v_and_b32 v161, 0xffff0000, v162
  v_lshlrev_b32 v163, 16, v130
  v_and_b32 v164, 0xffff0000, v130
  v_add_f32 v160, v160, v163
  v_add_f32 v161, v161, v164
  v_cvt_pk_bf16_f32 v166, v160, v161
  v_lshlrev_b32 v160, 16, v139
  v_and_b32 v161, 0xffff0000, v139
  v_add_f32 v160, v160, v150
  v_add_f32 v161, v161, v151
  v_cvt_pk_bf16_f32 v162, v160, v161
  v_lshlrev_b32 v160, 16, v162
  v_and_b32 v161, 0xffff0000, v162
  v_mul_f32 v163, 0xbfb8aa3b, v160
  v_mul_f32 v164, 0xbfb8aa3b, v161
  v_exp_f32 v163, v163
  v_exp_f32 v164, v164
  s_nop 0
  v_add_f32 v163, 1.0, v163
  v_add_f32 v164, 1.0, v164
  v_rcp_f32 v163, v163
  v_rcp_f32 v164, v164
  s_nop 0
  v_mul_f32 v160, v160, v163
  v_mul_f32 v161, v161, v164
  v_cvt_pk_bf16_f32 v162, v160, v161
  v_lshlrev_b32 v160, 16, v162
  v_and_b32 v161, 0xffff0000, v162
  v_cvt_pk_bf16_f32 v162, v22, v23
  v_lshlrev_b32 v163, 16, v162
  v_and_b32 v164, 0xffff0000, v162
  v_mul_f32 v160, v160, v163
  v_mul_f32 v161, v161, v164
  v_cvt_pk_bf16_f32 v162, v160, v161
  v_lshlrev_b32 v160, 16, v162
  v_and_b32 v161, 0xffff0000, v162
  v_lshlrev_b32 v163, 16, v131
  v_and_b32 v164, 0xffff0000, v131
  v_add_f32 v160, v160, v163
  v_add_f32 v161, v161, v164
  v_cvt_pk_bf16_f32 v167, v160, v161
  global_store_dwordx2 v7, v[166:167], s[6:7] offset:16
  s_nop 1
  v_lshlrev_b32 v160, 16, v140
  v_and_b32 v161, 0xffff0000, v140
  v_add_f32 v160, v160, v152
  v_add_f32 v161, v161, v153
  v_cvt_pk_bf16_f32 v162, v160, v161
  v_lshlrev_b32 v160, 16, v162
  v_and_b32 v161, 0xffff0000, v162
  v_mul_f32 v163, 0xbfb8aa3b, v160
  v_mul_f32 v164, 0xbfb8aa3b, v161
  v_exp_f32 v163, v163
  v_exp_f32 v164, v164
  s_nop 0
  v_add_f32 v163, 1.0, v163
  v_add_f32 v164, 1.0, v164
  v_rcp_f32 v163, v163
  v_rcp_f32 v164, v164
  s_nop 0
  v_mul_f32 v160, v160, v163
  v_mul_f32 v161, v161, v164
  v_cvt_pk_bf16_f32 v162, v160, v161
  v_lshlrev_b32 v160, 16, v162
  v_and_b32 v161, 0xffff0000, v162
  v_cvt_pk_bf16_f32 v162, v24, v25
  v_lshlrev_b32 v163, 16, v162
  v_and_b32 v164, 0xffff0000, v162
  v_mul_f32 v160, v160, v163
  v_mul_f32 v161, v161, v164
  v_cvt_pk_bf16_f32 v162, v160, v161
  v_lshlrev_b32 v160, 16, v162
  v_and_b32 v161, 0xffff0000, v162
  v_lshlrev_b32 v163, 16, v132
  v_and_b32 v164, 0xffff0000, v132
  v_add_f32 v160, v160, v163
  v_add_f32 v161, v161, v164
  v_cvt_pk_bf16_f32 v166, v160, v161
  v_lshlrev_b32 v160, 16, v141
  v_and_b32 v161, 0xffff0000, v141
  v_add_f32 v160, v160, v154
  v_add_f32 v161, v161, v155
  v_cvt_pk_bf16_f32 v162, v160, v161
  v_lshlrev_b32 v160, 16, v162
  v_and_b32 v161, 0xffff0000, v162
  v_mul_f32 v163, 0xbfb8aa3b, v160
  v_mul_f32 v164, 0xbfb8aa3b, v161
  v_exp_f32 v163, v163
  v_exp_f32 v164, v164
  s_nop 0
  v_add_f32 v163, 1.0, v163
  v_add_f32 v164, 1.0, v164
  v_rcp_f32 v163, v163
  v_rcp_f32 v164, v164
  s_nop 0
  v_mul_f32 v160, v160, v163
  v_mul_f32 v161, v161, v164
  v_cvt_pk_bf16_f32 v162, v160, v161
  v_lshlrev_b32 v160, 16, v162
  v_and_b32 v161, 0xffff0000, v162
  v_cvt_pk_bf16_f32 v162, v26, v27
  v_lshlrev_b32 v163, 16, v162
  v_and_b32 v164, 0xffff0000, v162
  v_mul_f32 v160, v160, v163
  v_mul_f32 v161, v161, v164
  v_cvt_pk_bf16_f32 v162, v160, v161
  v_lshlrev_b32 v160, 16, v162
  v_and_b32 v161, 0xffff0000, v162
  v_lshlrev_b32 v163, 16, v133
  v_and_b32 v164, 0xffff0000, v133
  v_add_f32 v160, v160, v163
  v_add_f32 v161, v161, v164
  v_cvt_pk_bf16_f32 v167, v160, v161
  global_store_dwordx2 v7, v[166:167], s[6:7] offset:32
  s_nop 1
  v_lshlrev_b32 v160, 16, v142
  v_and_b32 v161, 0xffff0000, v142
  v_add_f32 v160, v160, v156
  v_add_f32 v161, v161, v157
  v_cvt_pk_bf16_f32 v162, v160, v161
  v_lshlrev_b32 v160, 16, v162
  v_and_b32 v161, 0xffff0000, v162
  v_mul_f32 v163, 0xbfb8aa3b, v160
  v_mul_f32 v164, 0xbfb8aa3b, v161
  v_exp_f32 v163, v163
  v_exp_f32 v164, v164
  s_nop 0
  v_add_f32 v163, 1.0, v163
  v_add_f32 v164, 1.0, v164
  v_rcp_f32 v163, v163
  v_rcp_f32 v164, v164
  s_nop 0
  v_mul_f32 v160, v160, v163
  v_mul_f32 v161, v161, v164
  v_cvt_pk_bf16_f32 v162, v160, v161
  v_lshlrev_b32 v160, 16, v162
  v_and_b32 v161, 0xffff0000, v162
  v_cvt_pk_bf16_f32 v162, v28, v29
  v_lshlrev_b32 v163, 16, v162
  v_and_b32 v164, 0xffff0000, v162
  v_mul_f32 v160, v160, v163
  v_mul_f32 v161, v161, v164
  v_cvt_pk_bf16_f32 v162, v160, v161
  v_lshlrev_b32 v160, 16, v162
  v_and_b32 v161, 0xffff0000, v162
  v_lshlrev_b32 v163, 16, v134
  v_and_b32 v164, 0xffff0000, v134
  v_add_f32 v160, v160, v163
  v_add_f32 v161, v161, v164
  v_cvt_pk_bf16_f32 v166, v160, v161
  v_lshlrev_b32 v160, 16, v143
  v_and_b32 v161, 0xffff0000, v143
  v_add_f32 v160, v160, v158
  v_add_f32 v161, v161, v159
  v_cvt_pk_bf16_f32 v162, v160, v161
  v_lshlrev_b32 v160, 16, v162
  v_and_b32 v161, 0xffff0000, v162
  v_mul_f32 v163, 0xbfb8aa3b, v160
  v_mul_f32 v164, 0xbfb8aa3b, v161
  v_exp_f32 v163, v163
  v_exp_f32 v164, v164
  s_nop 0
  v_add_f32 v163, 1.0, v163
  v_add_f32 v164, 1.0, v164
  v_rcp_f32 v163, v163
  v_rcp_f32 v164, v164
  s_nop 0
  v_mul_f32 v160, v160, v163
  v_mul_f32 v161, v161, v164
  v_cvt_pk_bf16_f32 v162, v160, v161
  v_lshlrev_b32 v160, 16, v162
  v_and_b32 v161, 0xffff0000, v162
  v_cvt_pk_bf16_f32 v162, v30, v31
  v_lshlrev_b32 v163, 16, v162
  v_and_b32 v164, 0xffff0000, v162
  v_mul_f32 v160, v160, v163
  v_mul_f32 v161, v161, v164
  v_cvt_pk_bf16_f32 v162, v160, v161
  v_lshlrev_b32 v160, 16, v162
  v_and_b32 v161, 0xffff0000, v162
  v_lshlrev_b32 v163, 16, v135
  v_and_b32 v164, 0xffff0000, v135
  v_add_f32 v160, v160, v163
  v_add_f32 v161, v161, v164
  v_cvt_pk_bf16_f32 v167, v160, v161
  global_store_dwordx2 v7, v[166:167], s[6:7] offset:48
  s_nop 1
K3_end:
  s_endpgm
.section .rodata,"a"
.p2align 6
.amdhsa_kernel recurrent_scan__mha_block__moe_arch_mod__prompt_kernel
  .amdhsa_next_free_vgpr 64
  .amdhsa_next_free_sgpr 64
  .amdhsa_accum_offset 64
  .amdhsa_group_segment_fixed_size 0
  .amdhsa_kernarg_size 88
  .amdhsa_user_sgpr_count 2
  .amdhsa_user_sgpr_kernarg_segment_ptr 1
  .amdhsa_system_sgpr_workgroup_id_x 1
.end_amdhsa_kernel
.amdhsa_kernel k1_qkv_kernel
  .amdhsa_next_free_vgpr 256
  .amdhsa_next_free_sgpr 96
  .amdhsa_accum_offset 256
  .amdhsa_group_segment_fixed_size 0
  .amdhsa_kernarg_size 88
  .amdhsa_user_sgpr_count 2
  .amdhsa_user_sgpr_kernarg_segment_ptr 1
  .amdhsa_system_sgpr_workgroup_id_x 1
.end_amdhsa_kernel
.amdhsa_kernel k2_attn_kernel
  .amdhsa_next_free_vgpr 164
  .amdhsa_next_free_sgpr 96
  .amdhsa_accum_offset 164
  .amdhsa_group_segment_fixed_size 0
  .amdhsa_kernarg_size 88
  .amdhsa_user_sgpr_count 2
  .amdhsa_user_sgpr_kernarg_segment_ptr 1
  .amdhsa_system_sgpr_workgroup_id_x 1
.end_amdhsa_kernel
.amdhsa_kernel k3_out_kernel
  .amdhsa_next_free_vgpr 232
  .amdhsa_next_free_sgpr 64
  .amdhsa_accum_offset 232
  .amdhsa_group_segment_fixed_size 0
  .amdhsa_kernarg_size 88
  .amdhsa_user_sgpr_count 2
  .amdhsa_user_sgpr_kernarg_segment_ptr 1
  .amdhsa_system_sgpr_workgroup_id_x 1
.end_amdhsa_kernel
```
